```python
import torch

def _softmax(x, axis=-1):
    return torch.softmax(x, dim=axis)
def _gelu(x):
    return torch.nn.functional.gelu(x, approximate="tanh")
def _silu(x):
    return torch.nn.functional.silu(x)
def _sigmoid(x):
    return torch.sigmoid(x)
def _layernorm(x, axis=-1, eps=1e-5):
    m = x.mean(dim=axis, keepdim=True)
    v = x.var(dim=axis, keepdim=True, unbiased=False)
    return (x - m) / torch.sqrt(v + eps)
def _scatter_add(tgt, idx, src, axis=0):
    return tgt.clone().index_add_(axis, idx, src)
def _segment_sum(src, seg, n):
    out = torch.zeros((n,) + src.shape[1:], dtype=src.dtype)
    return out.index_add_(0, seg, src)
def _pad(x, pw):
    flat = tuple(v for pair in reversed(pw) for v in pair)
    return torch.nn.functional.pad(x, flat)

kernel_name = 'standalone__gqa_softmax__near_ridge'

def setup_inputs():

    _w = (lambda a: (lambda t: t.to(torch.bfloat16) if t.is_floating_point() else t)(torch.as_tensor(a)))
    B, Hq, Hkv, Sq, Sk, D = 8, 32, 8, 256, 512, 128
    return {
        "q": _w((lambda *s: torch.randn(*s, dtype=torch.bfloat16) * 0.8)(B, Hq, Sq, D)),
        "k": _w((lambda *s: torch.randn(*s, dtype=torch.bfloat16) * 0.8)(B, Hkv, Sk, D)),
        "v": _w((lambda *s: torch.randn(*s, dtype=torch.bfloat16) * 0.05)(B, Hkv, Sk, D)),
    }

def reference(q, k, v):
    B, Hq, Sq, D = q.shape
    Hkv = k.shape[1]
    rep = Hq // Hkv
    k = (lambda x, n, axis: torch.repeat_interleave(x, n, dim=axis))(k, rep, axis=1)
    v = (lambda x, n, axis: torch.repeat_interleave(x, n, dim=axis))(v, rep, axis=1)
    scale = D ** -0.5
    scores = torch.einsum("bhqd,bhkd->bhqk", q, k) * scale
    p = _softmax(scores, axis=-1)
    return torch.einsum("bhqk,bhkd->bhqd", p, v)
```

```asm
; @launch grid=(256,1,1) block=(256,1,1) lds=163840
.amdgcn_target "amdgcn-amd-amdhsa--gfx950"
.text
.p2align 12
.globl standalone__gqa_softmax__near_ridge_kernel
.p2align 8
.type standalone__gqa_softmax__near_ridge_kernel,@function
standalone__gqa_softmax__near_ridge_kernel:
    s_cmp_ge_u32 s2, 256
    s_cbranch_scc1 L_end
    s_load_dwordx2 s[16:17], s[0:1], 8
    s_load_dwordx2 s[12:13], s[0:1], 0
    s_getpc_b64 s[52:53]
L_pc:
    s_bfe_u32 s34, s2, 0x30003
    s_lshl_b32 s34, s34, 12
    v_lshl_add_u32 v2, v0, 4, s34
    global_load_dwordx4 v[252:255], v2, s[52:53]
    s_load_dwordx2 s[20:21], s[0:1], 16
    s_load_dwordx2 s[24:25], s[0:1], 24
    s_mov_b32 s48, 0
    v_mov_b32 v24, 0xff800000
    v_mov_b32 v25, 0xff800000
    v_mov_b32 v26, 0xff800000
    v_mov_b32 v27, 0xff800000
L_restart:
    v_lshrrev_b32 v1, 6, v0
    v_and_b32 v3, 15, v0
    v_readfirstlane_b32 s28, v1
    v_bfe_u32 v4, v0, 4, 2
    s_and_b32 s3, s2, 7
    s_lshr_b32 s29, s2, 3
    s_lshl_b32 s3, s3, 3
    s_lshr_b32 s34, s29, 2
    s_add_u32 s3, s3, s34
    s_and_b32 s29, s29, 3
    s_lshl_b32 s34, s3, 2
    s_add_u32 s29, s29, s34
    v_xor_b32 v5, v3, v4
    v_lshlrev_b32 v6, 8, v4
    v_lshl_add_u32 v32, v5, 4, v6
    v_xor_b32 v33, 64, v32
    v_xor_b32 v34, 128, v32
    v_xor_b32 v35, 192, v32
    s_lshl_b32 s44, s28, 12
    s_lshl_b32 s3, s3, 17
    s_add_u32 s36, s3, s44
    s_mov_b32 s8, s36
    s_lshr_b32 s9, s2, 5
    s_add_u32 s9, s9, s2
    s_and_b32 s9, s9, 7
    s_lshl_b32 s9, s9, 14
    s_add_u32 s36, s8, s9
    s_lshl_b32 s29, s29, 16
    s_lshl_b32 s34, s28, 14
    s_add_u32 s30, s29, s34
    s_mov_b32 s10, s30
    s_lshl_b32 s11, s2, 9
    s_and_b32 s11, s11, 0x3000
    s_add_u32 s30, s10, s11
    v_lshlrev_b32 v1, 8, v3
    s_mov_b32 s18, 0x800000
    s_mov_b32 s19, 0x20000
    s_mov_b32 s14, 0x1000000
    s_mov_b32 s15, 0x20000
    s_mov_b32 s22, 0x800000
    s_mov_b32 s23, 0x20000
    s_mov_b32 s26, 0x1000000
    s_mov_b32 s27, 0x20000
    s_waitcnt lgkmcnt(0)
    s_add_u32 m0, s44, 0x0
    s_add_u32 s31, s11, 0x1000
    s_and_b32 s31, s31, 0x3000
    s_add_u32 s31, s31, s10
    buffer_load_dwordx4 v32, s[16:19], s36 offen offset:0 lds
    buffer_load_dwordx4 v33, s[16:19], s36 offen offset:1024 lds
    buffer_load_dwordx4 v34, s[16:19], s36 offen offset:2048 lds
    buffer_load_dwordx4 v35, s[16:19], s36 offen offset:3072 lds
    s_add_u32 m0, s44, 0x20000
    s_add_u32 s32, s11, 0x2000
    s_and_b32 s32, s32, 0x3000
    s_add_u32 s32, s32, s10
    buffer_load_dwordx4 v32, s[12:15], s30 offen offset:0 lds
    buffer_load_dwordx4 v33, s[12:15], s30 offen offset:1024 lds
    buffer_load_dwordx4 v34, s[12:15], s30 offen offset:2048 lds
    buffer_load_dwordx4 v35, s[12:15], s30 offen offset:3072 lds
    v_lshlrev_b32 v5, 2, v4
    v_xor_b32 v5, v3, v5
    v_lshl_add_u32 v30, v5, 4, v6
    s_add_u32 m0, s44, 0x10000
    s_add_u32 s33, s11, 0x3000
    s_and_b32 s33, s33, 0x3000
    s_add_u32 s33, s33, s10
    buffer_load_dwordx4 v30, s[20:23], s36 offen offset:0 lds
    buffer_load_dwordx4 v30, s[20:23], s36 offen offset:1024 lds
    buffer_load_dwordx4 v30, s[20:23], s36 offen offset:2048 lds
    buffer_load_dwordx4 v30, s[20:23], s36 offen offset:3072 lds
    s_add_u32 s34, s44, 0x18000
    s_add_u32 s37, s9, 0x4000
    s_and_b32 s37, s37, 0x1c000
    s_add_u32 s37, s37, s8
    s_add_u32 s38, s9, 0x8000
    s_and_b32 s38, s38, 0x1c000
    s_add_u32 s38, s38, s8
    s_add_u32 s39, s9, 0xc000
    s_and_b32 s39, s39, 0x1c000
    s_add_u32 s39, s39, s8
    s_add_u32 s40, s9, 0x10000
    s_and_b32 s40, s40, 0x1c000
    s_add_u32 s40, s40, s8
    s_add_u32 s41, s9, 0x14000
    s_and_b32 s41, s41, 0x1c000
    s_add_u32 s41, s41, s8
    s_add_u32 s42, s9, 0x18000
    s_and_b32 s42, s42, 0x1c000
    s_add_u32 s42, s42, s8
    s_add_u32 s43, s9, 0x1c000
    s_and_b32 s43, s43, 0x1c000
    s_add_u32 s43, s43, s8
    s_mov_b64 s[46:47], 0
    v_xor_b32 v5, v3, v4
    v_lshl_add_u32 v44, v5, 4, v1
    v_xor_b32 v45, 64, v44
    v_xor_b32 v46, 128, v44
    v_xor_b32 v47, 192, v44
    v_add_u32 v16, s34, v44
    v_add_u32 v17, s34, v45
    v_add_u32 v18, s34, v46
    v_add_u32 v19, s34, v47
    v_lshrrev_b32 v5, 2, v3
    v_cmp_eq_u32 vcc, v5, v4
    v_and_b32 v5, 1, v3
    v_mov_b32 v11, 0xb9d8
    v_mov_b32 v10, 0x3e03
    v_lshlrev_b32 v5, 4, v5
    v_mov_b32 v8, 0
    v_and_b32 v6, 2, v3
    v_cndmask_b32 v6, 4, v6, vcc
    v_lshlrev_b32 v9, v5, v10
    v_lshlrev_b32 v11, v5, v11
    v_cmp_eq_u32 vcc, 0, v6
    v_accvgpr_write_b32 a208, v8
    v_accvgpr_write_b32 a209, v8
    v_accvgpr_write_b32 a212, v8
    v_accvgpr_write_b32 a213, v8
    v_accvgpr_write_b32 a216, v8
    v_accvgpr_write_b32 a217, v8
    v_cndmask_b32 v12, v8, v9, vcc
    v_cndmask_b32 v13, v8, v11, vcc
    v_cmp_eq_u32 vcc, 2, v6
    v_accvgpr_write_b32 a210, v12
    v_accvgpr_write_b32 a214, v13
    v_cndmask_b32 v12, v8, v9, vcc
    v_cndmask_b32 v13, v8, v11, vcc
    v_accvgpr_write_b32 a211, v12
    v_accvgpr_write_b32 a215, v13
    v_bfe_u32 v5, v0, 2, 4
    v_and_b32 v6, 3, v5
    v_lshlrev_b32 v6, 6, v6
    v_lshl_add_u32 v6, v5, 8, v6
    v_and_b32 v5, 3, v0
    v_lshl_add_u32 v6, v5, 4, v6
    v_add_u32 v36, 0x10000, v6
    v_xor_b32 v37, 64, v36
    v_xor_b32 v38, 128, v36
    v_xor_b32 v39, 192, v36
    v_lshl_add_u32 v28, v4, 4, v1
    v_and_b32 v5, 1, v0
    v_cmp_eq_u32 vcc, 0, v5
    v_mov_b32 v6, 0x44444444
    v_mov_b32 v5, 0xeeeeeeee
    v_cndmask_b32 v29, v5, v6, vcc
    v_accvgpr_write_b32 a192, 0
    v_accvgpr_write_b32 a193, 0
    v_accvgpr_write_b32 a194, 0
    v_accvgpr_write_b32 a195, 0
    v_accvgpr_write_b32 a196, 0
    v_accvgpr_write_b32 a197, 0
    v_accvgpr_write_b32 a198, 0
    v_accvgpr_write_b32 a199, 0
    v_accvgpr_write_b32 a200, 0
    v_accvgpr_write_b32 a201, 0
    v_accvgpr_write_b32 a202, 0
    v_accvgpr_write_b32 a203, 0
    v_accvgpr_write_b32 a204, 0
    v_accvgpr_write_b32 a205, 0
    v_accvgpr_write_b32 a206, 0
    v_accvgpr_write_b32 a207, 0
    v_and_b32 v5, 2, v0
    v_cmp_eq_u32 vcc, 0, v5
    v_mov_b32 v6, 0x3f803f80
    s_nop 0
    v_cndmask_b32 v20, 0, v6, vcc
    v_cndmask_b32 v21, 0, v6, vcc
    v_cndmask_b32 v22, 0, v6, vcc
    v_cndmask_b32 v23, 0, v6, vcc
    s_add_u32 m0, s44, 0x18000
    s_nop 0
    buffer_load_dwordx4 v32, s[12:15], s31 offen offset:0 lds
    buffer_load_dwordx4 v33, s[12:15], s31 offen offset:1024 lds
    buffer_load_dwordx4 v34, s[12:15], s31 offen offset:2048 lds
    buffer_load_dwordx4 v35, s[12:15], s31 offen offset:3072 lds
    s_waitcnt vmcnt(12)
    s_barrier
    ds_read_b128 a[64:67], v44 offset:0
    ds_read_b128 a[68:71], v45 offset:0
    ds_read_b128 a[72:75], v46 offset:0
    ds_read_b128 a[76:79], v47 offset:0
    ds_read_b128 a[80:83], v44 offset:4096
    ds_read_b128 a[84:87], v45 offset:4096
    ds_read_b128 a[88:91], v46 offset:4096
    ds_read_b128 a[92:95], v47 offset:4096
    ds_read_b128 a[96:99], v44 offset:8192
    ds_read_b128 a[100:103], v45 offset:8192
    ds_read_b128 a[104:107], v46 offset:8192
    ds_read_b128 a[108:111], v47 offset:8192
    ds_read_b128 a[112:115], v44 offset:12288
    ds_read_b128 a[116:119], v45 offset:12288
    ds_read_b128 a[120:123], v46 offset:12288
    ds_read_b128 a[124:127], v47 offset:12288
    s_mov_b64 exec, 0
    s_cmp_eq_u32 s28, 0
    s_cbranch_scc1 L_pg0
    s_cmp_eq_u32 s28, 1
    s_cbranch_scc1 L_pg1
    s_cmp_eq_u32 s28, 2
    s_cbranch_scc1 L_pg2
    s_branch L_pg3
L_pgret0:
L_pgret1:
L_pgret2:
L_pgret3:
    s_mov_b64 exec, -1
    s_waitcnt vmcnt(8)
    ds_read_b128 a[0:3], v16 offset:32768
    ds_read_b128 a[4:7], v17 offset:32768
    ds_read_b128 a[8:11], v18 offset:32768
    ds_read_b128 a[12:15], v19 offset:32768
    s_add_u32 m0, s44, 0x4000
    s_nop 0
    buffer_load_dwordx4 v32, s[16:19], s37 offen offset:0 lds
    s_nop 14
    buffer_load_dwordx4 v33, s[16:19], s37 offen offset:1024 lds
    s_waitcnt lgkmcnt(3)
    v_mfma_f32_16x16x32_bf16 v[64:67], a[210:213], a[0:3], 0
    v_mfma_f32_16x16x32_bf16 v[64:67], a[214:217], a[0:3], v[64:67]
    s_nop 2
    v_mfma_f32_16x16x32_bf16 v[68:71], a[208:211], a[0:3], 0
    s_nop 2
    buffer_load_dwordx4 v34, s[16:19], s37 offen offset:2048 lds
    v_mfma_f32_16x16x32_bf16 v[68:71], a[212:215], a[0:3], v[68:71]
    s_waitcnt lgkmcnt(0)
    v_cvt_pk_bf16_f32 v8, v64, v65
    v_cvt_pk_bf16_f32 v9, v66, v67
    v_mfma_f32_16x16x32_bf16 v[72:75], a[210:213], a[4:7], 0
    v_accvgpr_write_b32 a0, v8
    v_accvgpr_write_b32 a1, v9
    v_mfma_f32_16x16x32_bf16 v[72:75], a[214:217], a[4:7], v[72:75]
    s_nop 2
    v_mfma_f32_16x16x32_bf16 v[76:79], a[208:211], a[4:7], 0
    v_cvt_pk_bf16_f32 v10, v68, v69
    buffer_load_dwordx4 v35, s[16:19], s37 offen offset:3072 lds
    v_mfma_f32_16x16x32_bf16 v[76:79], a[212:215], a[4:7], v[76:79]
    v_cvt_pk_bf16_f32 v11, v70, v71
    v_cvt_pk_bf16_f32 v12, v72, v73
    v_mfma_f32_16x16x32_bf16 v[64:67], a[210:213], a[8:11], 0
    v_cvt_pk_bf16_f32 v13, v74, v75
    v_accvgpr_write_b32 a2, v10
    v_mfma_f32_16x16x32_bf16 v[64:67], a[214:217], a[8:11], v[64:67]
    v_accvgpr_write_b32 a3, v11
    v_accvgpr_write_b32 a4, v12
    v_mfma_f32_16x16x32_bf16 v[68:71], a[208:211], a[8:11], 0
    v_cvt_pk_bf16_f32 v14, v76, v77
    v_cvt_pk_bf16_f32 v15, v78, v79
    v_mfma_f32_16x16x32_bf16 v[68:71], a[212:215], a[8:11], v[68:71]
    v_accvgpr_write_b32 a5, v13
    v_accvgpr_write_b32 a6, v14
    v_mfma_f32_16x16x32_bf16 v[72:75], a[210:213], a[12:15], 0
    v_accvgpr_write_b32 a7, v15
    v_cvt_pk_bf16_f32 v8, v64, v65
    v_mfma_f32_16x16x32_bf16 v[72:75], a[214:217], a[12:15], v[72:75]
    v_cvt_pk_bf16_f32 v9, v66, v67
    v_accvgpr_write_b32 a8, v8
    v_mfma_f32_16x16x32_bf16 v[76:79], a[208:211], a[12:15], 0
    v_accvgpr_write_b32 a9, v9
    v_cvt_pk_bf16_f32 v10, v68, v69
    v_mfma_f32_16x16x32_bf16 v[76:79], a[212:215], a[12:15], v[76:79]
    v_cvt_pk_bf16_f32 v11, v70, v71
    v_accvgpr_write_b32 a10, v10
    v_mfma_f32_16x16x32_bf16 v[64:67], a[64:67], a[0:3], 0
    v_accvgpr_write_b32 a11, v11
    v_cvt_pk_bf16_f32 v12, v72, v73
    v_mfma_f32_16x16x32_bf16 v[64:67], a[68:71], a[4:7], v[64:67]
    v_accvgpr_write_b32 a12, v12
    v_cvt_pk_bf16_f32 v13, v74, v75
    v_mfma_f32_16x16x32_bf16 v[68:71], a[80:83], a[0:3], 0
    v_accvgpr_write_b32 a13, v13
    v_cvt_pk_bf16_f32 v14, v76, v77
    v_mfma_f32_16x16x32_bf16 v[68:71], a[84:87], a[4:7], v[68:71]
    v_accvgpr_write_b32 a14, v14
    v_cvt_pk_bf16_f32 v15, v78, v79
    v_mfma_f32_16x16x32_bf16 v[64:67], a[72:75], a[8:11], v[64:67]
    v_accvgpr_write_b32 a15, v15
    v_mfma_f32_16x16x32_bf16 v[68:71], a[88:91], a[8:11], v[68:71]
    s_nop 0
    v_mfma_f32_16x16x32_bf16 v[64:67], a[76:79], a[12:15], v[64:67]
    s_nop 2
    v_mfma_f32_16x16x32_bf16 v[68:71], a[92:95], a[12:15], v[68:71]
    s_nop 2
    v_mfma_f32_16x16x32_bf16 v[72:75], a[96:99], a[0:3], 0
    v_max3_f32 v8, v64, v65, v66
    v_max3_f32 v8, v8, v67, v24
    v_mfma_f32_16x16x32_bf16 v[72:75], a[100:103], a[4:7], v[72:75]
    v_mov_b32 v9, v8
    v_mfma_f32_16x16x32_bf16 v[72:75], a[104:107], a[8:11], v[72:75]
    v_mfma_f32_16x16x32_bf16 v[72:75], a[108:111], a[12:15], v[72:75]
    v_permlane16_swap_b32 v8, v9
    v_mfma_f32_16x16x32_bf16 v[76:79], a[112:115], a[0:3], 0
    v_max_f32 v8, v8, v9
    v_mov_b32 v9, v8
    v_mfma_f32_16x16x32_bf16 v[76:79], a[116:119], a[4:7], v[76:79]
    v_mfma_f32_16x16x32_bf16 v[76:79], a[120:123], a[8:11], v[76:79]
    v_permlane32_swap_b32 v8, v9
    v_min_f32 v48, -v8, -v9
    v_min_f32 v49, -v8, -v9
    v_min_f32 v50, -v8, -v9
    v_min_f32 v51, -v8, -v9
    v_add_f32 v64, v64, v48
    v_exp_f32 v64, v64
    v_add_f32 v65, v65, v49
    v_exp_f32 v65, v65
    v_add_f32 v66, v66, v50
    v_exp_f32 v66, v66
    v_add_f32 v67, v67, v51
    v_exp_f32 v67, v67
    v_add_f32 v68, v68, v48
    v_exp_f32 v68, v68
    v_add_f32 v69, v69, v49
    v_exp_f32 v69, v69
    v_add_f32 v70, v70, v50
    s_mov_b64 exec, 0
    s_cmp_eq_u32 s28, 0
    s_cbranch_scc1 L_pg4
L_pgret4:
    s_mov_b64 exec, -1
    s_branch L_main
.p2align 12
.fill 0, 4, 0xbf800000
L_main:
L_pg0:
    s_cbranch_execz L_pgret0
    s_waitcnt vmcnt(8)
    s_add_u32 m0, s44, 0x14000
    s_barrier
    buffer_load_dwordx4 v30, s[20:23], s37 offen offset:0 lds
    ds_read_b64_tr_b16 a[128:129], v36 offset:0
    ds_read_b64_tr_b16 a[130:131], v36 offset:4096
    ds_read_b64_tr_b16 a[132:133], v36 offset:8
    ds_read_b64_tr_b16 a[134:135], v36 offset:4104
    ds_read_b64_tr_b16 a[136:137], v37 offset:0
    ds_read_b64_tr_b16 a[138:139], v37 offset:4096
    ds_read_b64_tr_b16 a[140:141], v37 offset:8
    ds_read_b64_tr_b16 a[142:143], v37 offset:4104
    buffer_load_dwordx4 v30, s[20:23], s37 offen offset:1024 lds
    ds_read_b64_tr_b16 a[144:145], v38 offset:0
    ds_read_b64_tr_b16 a[146:147], v38 offset:4096
    ds_read_b64_tr_b16 a[148:149], v38 offset:8
    ds_read_b64_tr_b16 a[150:151], v38 offset:4104
    ds_read_b64_tr_b16 a[152:153], v39 offset:0
    ds_read_b64_tr_b16 a[154:155], v39 offset:4096
    ds_read_b64_tr_b16 a[156:157], v39 offset:8
    v_exp_f32 v70, v70
    buffer_load_dwordx4 v30, s[20:23], s37 offen offset:2048 lds
    v_add_f32 v71, v71, v51
    v_exp_f32 v71, v71
    ds_read_b64_tr_b16 a[158:159], v39 offset:4104
    v_mfma_f32_16x16x32_bf16 v[76:79], a[124:127], a[12:15], v[76:79]
    v_cvt_pk_bf16_f32 v64, v64, v65
    v_cvt_pk_bf16_f32 v65, v66, v67
    v_cvt_pk_bf16_f32 v66, v68, v69
    v_cvt_pk_bf16_f32 v67, v70, v71
    ds_read_b64_tr_b16 a[160:161], v36 offset:8192
    buffer_load_dwordx4 v30, s[20:23], s37 offen offset:3072 lds
    s_waitcnt lgkmcnt(7)
    v_mfma_f32_16x16x32_bf16 v[128:131], a[128:131], v[64:67], 0
    ds_read_b64_tr_b16 a[162:163], v36 offset:12288
    v_add_f32 v76, v76, v48
    v_mfma_f32_16x16x32_bf16 v[132:135], a[132:135], v[64:67], 0
    ds_read_b64_tr_b16 a[174:175], v37 offset:12296
    v_add_f32 v79, v79, v51
    v_mfma_f32_16x16x32_bf16 v[136:139], a[136:139], v[64:67], 0
    ds_read_b64_tr_b16 a[182:183], v38 offset:12296
    v_add_f32 v72, v72, v48
    v_mfma_f32_16x16x32_bf16 v[140:143], a[140:143], v[64:67], 0
    ds_read_b64_tr_b16 a[168:169], v37 offset:8192
    v_add_f32 v73, v73, v49
    v_mfma_f32_16x16x32_bf16 v[144:147], a[144:147], v[64:67], 0
    s_waitcnt lgkmcnt(6)
    ds_read_b64_tr_b16 a[166:167], v36 offset:12296
    v_mfma_f32_16x16x32_bf16 v[148:151], a[148:151], v[64:67], 0
    ds_read_b64_tr_b16 a[186:187], v39 offset:12288
    v_add_f32 v75, v75, v51
    v_mfma_f32_16x16x32_bf16 v[152:155], a[152:155], v[64:67], 0
    s_waitcnt lgkmcnt(7)
    v_exp_f32 v72, v72
    v_mfma_f32_16x16x32_bf16 v[156:159], a[156:159], v[64:67], 0
    ds_read_b64_tr_b16 a[178:179], v38 offset:12288
    v_add_f32 v77, v77, v49
    v_exp_f32 v79, v79
    v_add_f32 v74, v74, v50
    v_exp_f32 v76, v76
    v_exp_f32 v73, v73
    v_exp_f32 v77, v77
    v_exp_f32 v74, v74
    ds_read_b64_tr_b16 a[164:165], v36 offset:8200
    v_add_f32 v78, v78, v50
    ds_read_b64_tr_b16 a[176:177], v38 offset:8192
    ds_read_b64_tr_b16 a[188:189], v39 offset:8200
    v_exp_f32 v78, v78
    ds_read_b64_tr_b16 a[190:191], v39 offset:12296
    v_cvt_pk_bf16_f32 v70, v76, v77
    v_cvt_pk_bf16_f32 v71, v78, v79
    ds_read_b64_tr_b16 a[170:171], v37 offset:12288
    ds_read_b64_tr_b16 a[172:173], v37 offset:8200
    ds_read_b64_tr_b16 a[184:185], v39 offset:8192
    ds_read_b64_tr_b16 a[180:181], v38 offset:8200
    v_exp_f32 v75, v75
    v_cvt_pk_bf16_f32 v68, v72, v73
    v_cvt_pk_bf16_f32 v69, v74, v75
    s_waitcnt vmcnt(8)
    s_add_u32 m0, s44, 0x1c000
    ds_read_b128 a[16:19], v16 offset:0
    buffer_load_dwordx4 v32, s[12:15], s32 offen offset:0 lds
    ds_read_b128 a[20:23], v17 offset:0
    ds_read_b128 a[24:27], v18 offset:0
    ds_read_b128 a[28:31], v19 offset:0
    s_nop 8
    buffer_load_dwordx4 v33, s[12:15], s32 offen offset:1024 lds
    s_waitcnt lgkmcnt(3)
    v_mfma_f32_16x16x32_bf16 v[80:83], a[210:213], a[16:19], 0
    v_mfma_f32_16x16x32_bf16 v[80:83], a[214:217], a[16:19], v[80:83]
    buffer_load_dwordx4 v34, s[12:15], s32 offen offset:2048 lds
    v_mfma_f32_16x16x32_bf16 v[84:87], a[208:211], a[16:19], 0
    v_mfma_f32_16x16x32_bf16 v[84:87], a[212:215], a[16:19], v[84:87]
    s_waitcnt lgkmcnt(0)
    v_mfma_f32_16x16x32_bf16 v[88:91], a[210:213], a[20:23], 0
    v_mfma_f32_16x16x32_bf16 v[88:91], a[214:217], a[20:23], v[88:91]
    s_nop 0
    v_mfma_f32_16x16x32_bf16 v[92:95], a[208:211], a[20:23], 0
    buffer_load_dwordx4 v35, s[12:15], s32 offen offset:3072 lds
    v_cvt_pk_bf16_f32 v10, v80, v81
    v_mfma_f32_16x16x32_bf16 v[92:95], a[212:215], a[20:23], v[92:95]
    v_cvt_pk_bf16_f32 v11, v82, v83
    v_cvt_pk_bf16_f32 v13, v86, v87
    v_mfma_f32_16x16x32_bf16 v[80:83], a[210:213], a[24:27], 0
    v_mfma_f32_16x16x32_bf16 v[80:83], a[214:217], a[24:27], v[80:83]
    v_cvt_pk_bf16_f32 v12, v84, v85
    v_accvgpr_write_b32 a19, v13
    v_cvt_pk_bf16_f32 v14, v88, v89
    v_mfma_f32_16x16x32_bf16 v[84:87], a[208:211], a[24:27], 0
    v_cvt_pk_bf16_f32 v15, v90, v91
    v_mfma_f32_16x16x32_bf16 v[84:87], a[212:215], a[24:27], v[84:87]
    v_mfma_f32_16x16x32_bf16 v[88:91], a[210:213], a[28:31], 0
    v_accvgpr_write_b32 a18, v12
    v_cvt_pk_bf16_f32 v9, v94, v95
    v_mfma_f32_16x16x32_bf16 v[88:91], a[214:217], a[28:31], v[88:91]
    v_accvgpr_write_b32 a17, v11
    v_accvgpr_write_b32 a20, v14
    v_cvt_pk_bf16_f32 v8, v92, v93
    v_mfma_f32_16x16x32_bf16 v[92:95], a[208:211], a[28:31], 0
    v_accvgpr_write_b32 a16, v10
    v_accvgpr_write_b32 a22, v8
    v_cvt_pk_bf16_f32 v11, v82, v83
    v_accvgpr_write_b32 a25, v11
    v_mfma_f32_16x16x32_bf16 v[92:95], a[212:215], a[28:31], v[92:95]
    v_accvgpr_write_b32 a21, v15
    v_accvgpr_write_b32 a23, v9
    v_cvt_pk_bf16_f32 v10, v80, v81
    v_mfma_f32_16x16x32_bf16 v[80:83], a[64:67], a[16:19], 0
    v_cvt_pk_bf16_f32 v12, v84, v85
    v_accvgpr_write_b32 a26, v12
    v_cvt_pk_bf16_f32 v13, v86, v87
    v_accvgpr_write_b32 a27, v13
    v_mfma_f32_16x16x32_bf16 v[80:83], a[68:71], a[20:23], v[80:83]
    v_cvt_pk_bf16_f32 v14, v88, v89
    v_accvgpr_write_b32 a28, v14
    v_mfma_f32_16x16x32_bf16 v[84:87], a[80:83], a[16:19], 0
    v_accvgpr_write_b32 a24, v10
    v_cvt_pk_bf16_f32 v15, v90, v91
    v_mfma_f32_16x16x32_bf16 v[84:87], a[84:87], a[20:23], v[84:87]
    v_accvgpr_write_b32 a29, v15
    v_cvt_pk_bf16_f32 v9, v94, v95
    v_mfma_f32_16x16x32_bf16 v[80:83], a[72:75], a[24:27], v[80:83]
    v_cvt_pk_bf16_f32 v8, v92, v93
    v_accvgpr_write_b32 a30, v8
    v_accvgpr_write_b32 a31, v9
    v_mfma_f32_16x16x32_bf16 v[84:87], a[88:91], a[24:27], v[84:87]
    s_nop 0
    v_mfma_f32_16x16x32_bf16 v[80:83], a[76:79], a[28:31], v[80:83]
    v_mfma_f32_16x16x32_bf16 v[84:87], a[92:95], a[28:31], v[84:87]
    v_mfma_f32_16x16x32_bf16 v[128:131], a[160:163], v[68:71], v[128:131]
    v_mfma_f32_16x16x32_bf16 v[132:135], a[164:167], v[68:71], v[132:135]
    s_nop 2
    v_mfma_f32_16x16x32_bf16 v[136:139], a[168:171], v[68:71], v[136:139]
    v_mfma_f32_16x16x32_bf16 v[140:143], a[172:175], v[68:71], v[140:143]
    v_max3_f32 v10, v80, v81, v82
    v_max3_f32 v10, v10, v83, v25
    v_mov_b32 v11, v10
    v_mfma_f32_16x16x32_bf16 v[144:147], a[176:179], v[68:71], v[144:147]
    v_mfma_f32_16x16x32_bf16 v[148:151], a[180:183], v[68:71], v[148:151]
    v_permlane16_swap_b32 v10, v11
    v_max_f32 v10, v10, v11
    v_mov_b32 v11, v10
    v_mfma_f32_16x16x32_bf16 v[152:155], a[184:187], v[68:71], v[152:155]
    v_mfma_f32_16x16x32_bf16 v[156:159], a[188:191], v[68:71], v[156:159]
    v_permlane32_swap_b32 v10, v11
    v_min_f32 v52, -v10, -v11
    v_min_f32 v54, -v10, -v11
    v_min_f32 v55, -v10, -v11
    v_add_f32 v80, v80, v52
    v_add_f32 v82, v82, v54
    v_min_f32 v53, -v10, -v11
    v_exp_f32 v80, v80
    v_add_f32 v81, v81, v53
    v_add_f32 v87, v87, v55
    v_exp_f32 v87, v87
    v_smfmac_f32_16x16x64_bf16 a[192:195], v[20:23], v[64:71], v29
    v_exp_f32 v81, v81
    v_mfma_f32_16x16x32_bf16 v[88:91], a[96:99], a[16:19], v[52:55]
    v_add_f32 v85, v85, v53
    v_cvt_pk_bf16_f32 v80, v80, v81
    v_mfma_f32_16x16x32_bf16 v[88:91], a[100:103], a[20:23], v[88:91]
    v_add_f32 v83, v83, v55
    v_add_f32 v84, v84, v52
    v_mfma_f32_16x16x32_bf16 v[88:91], a[104:107], a[24:27], v[88:91]
    v_exp_f32 v82, v82
    v_mfma_f32_16x16x32_bf16 v[88:91], a[108:111], a[28:31], v[88:91]
    v_exp_f32 v84, v84
    v_exp_f32 v85, v85
    v_mfma_f32_16x16x32_bf16 v[92:95], a[112:115], a[16:19], v[52:55]
    v_exp_f32 v83, v83
    v_mfma_f32_16x16x32_bf16 v[92:95], a[116:119], a[20:23], v[92:95]
    v_add_f32 v86, v86, v54
    v_exp_f32 v86, v86
    v_mfma_f32_16x16x32_bf16 v[92:95], a[120:123], a[24:27], v[92:95]
    s_waitcnt vmcnt(8)
    v_cvt_pk_bf16_f32 v81, v82, v83
    v_cvt_pk_bf16_f32 v82, v84, v85
    v_cvt_pk_bf16_f32 v83, v86, v87
    v_mfma_f32_16x16x32_bf16 v[92:95], a[124:127], a[28:31], v[92:95]
    s_barrier
    v_mfma_f32_16x16x32_bf16 v[160:163], a[128:131], v[80:83], 0
    s_add_u32 m0, s44, 0x8000
    v_exp_f32 v88, v88
    v_mfma_f32_16x16x32_bf16 v[164:167], a[132:135], v[80:83], 0
    ds_read_b128 a[76:79], v47 offset:16384
    v_exp_f32 v89, v89
    v_mfma_f32_16x16x32_bf16 v[168:171], a[136:139], v[80:83], 0
    buffer_load_dwordx4 v32, s[16:19], s38 offen offset:0 lds
    v_exp_f32 v91, v91
    v_mfma_f32_16x16x32_bf16 v[172:175], a[140:143], v[80:83], 0
    ds_read_b128 a[96:99], v44 offset:24576
    v_exp_f32 v90, v90
    v_exp_f32 v93, v93
    v_exp_f32 v94, v94
    v_exp_f32 v95, v95
    v_cvt_pk_bf16_f32 v84, v88, v89
    v_mfma_f32_16x16x32_bf16 v[176:179], a[144:147], v[80:83], 0
    ds_read_b128 a[64:67], v44 offset:16384
    v_exp_f32 v92, v92
    v_mfma_f32_16x16x32_bf16 v[180:183], a[148:151], v[80:83], 0
    v_cvt_pk_bf16_f32 v86, v92, v93
    v_cvt_pk_bf16_f32 v87, v94, v95
    v_mfma_f32_16x16x32_bf16 v[184:187], a[152:155], v[80:83], 0
    ds_read_b128 a[68:71], v45 offset:16384
    v_cvt_pk_bf16_f32 v85, v90, v91
    v_mfma_f32_16x16x32_bf16 v[188:191], a[156:159], v[80:83], 0
    ds_read_b128 a[88:91], v46 offset:20480
    ds_read_b128 a[100:103], v45 offset:24576
    v_mfma_f32_16x16x32_bf16 v[160:163], a[160:163], v[84:87], v[160:163]
    buffer_load_dwordx4 v33, s[16:19], s38 offen offset:1024 lds
    v_mfma_f32_16x16x32_bf16 v[164:167], a[164:167], v[84:87], v[164:167]
    ds_read_b128 a[72:75], v46 offset:16384
    v_mfma_f32_16x16x32_bf16 v[168:171], a[168:171], v[84:87], v[168:171]
    ds_read_b128 a[124:127], v47 offset:28672
    v_mfma_f32_16x16x32_bf16 v[172:175], a[172:175], v[84:87], v[172:175]
    ds_read_b128 a[80:83], v44 offset:20480
    ds_read_b128 a[92:95], v47 offset:20480
    v_mfma_f32_16x16x32_bf16 v[176:179], a[176:179], v[84:87], v[176:179]
    ds_read_b128 a[84:87], v45 offset:20480
    v_mfma_f32_16x16x32_bf16 v[180:183], a[180:183], v[84:87], v[180:183]
    buffer_load_dwordx4 v34, s[16:19], s38 offen offset:2048 lds
    v_mfma_f32_16x16x32_bf16 v[184:187], a[184:187], v[84:87], v[184:187]
    ds_read_b128 a[108:111], v47 offset:24576
    v_mfma_f32_16x16x32_bf16 v[188:191], a[188:191], v[84:87], v[188:191]
    ds_read_b128 a[116:119], v45 offset:28672
    v_smfmac_f32_16x16x64_bf16 a[196:199], v[20:23], v[80:87], v29
L_s1:
    s_waitcnt lgkmcnt(7)
    ds_read_b128 a[112:115], v44 offset:28672
    v_mfma_f32_16x16x32_bf16 v[64:67], a[64:67], a[0:3], v[48:51]
    ds_read_b128 a[104:107], v46 offset:24576
    ds_read_b128 a[120:123], v46 offset:28672
    v_mfma_f32_16x16x32_bf16 v[64:67], a[68:71], a[4:7], v[64:67]
    s_waitcnt lgkmcnt(9)
    buffer_load_dwordx4 v35, s[16:19], s38 offen offset:3072 lds
    v_mfma_f32_16x16x32_bf16 v[64:67], a[72:75], a[8:11], v[64:67]
    s_waitcnt vmcnt(8)
    s_barrier
    v_mfma_f32_16x16x32_bf16 v[64:67], a[76:79], a[12:15], v[64:67]
    s_waitcnt lgkmcnt(5)
    s_add_u32 m0, s44, 0x18000
    ds_read_b64_tr_b16 a[136:137], v37 offset:16384
    v_mfma_f32_16x16x32_bf16 v[68:71], a[80:83], a[0:3], v[48:51]
    ds_read_b64_tr_b16 a[160:161], v36 offset:24576
    ds_read_b64_tr_b16 a[142:143], v37 offset:20488
    v_mfma_f32_16x16x32_bf16 v[68:71], a[84:87], a[4:7], v[68:71]
    ds_read_b64_tr_b16 a[166:167], v36 offset:28680
    ds_read_b64_tr_b16 a[138:139], v37 offset:20480
    v_mfma_f32_16x16x32_bf16 v[68:71], a[88:91], a[8:11], v[68:71]
    buffer_load_dwordx4 v30, s[20:23], s38 offen offset:0 lds
    v_mfma_f32_16x16x32_bf16 v[68:71], a[92:95], a[12:15], v[68:71]
    ds_read_b64_tr_b16 a[190:191], v39 offset:28680
    v_exp_f32 v65, v65
    v_mfma_f32_16x16x32_bf16 v[72:75], a[96:99], a[0:3], v[48:51]
    ds_read_b64_tr_b16 a[164:165], v36 offset:24584
    v_exp_f32 v64, v64
    v_mfma_f32_16x16x32_bf16 v[72:75], a[100:103], a[4:7], v[72:75]
    s_waitcnt lgkmcnt(7)
    ds_read_b64_tr_b16 a[168:169], v37 offset:24576
    v_cvt_pk_bf16_f32 v64, v64, v65
    v_mfma_f32_16x16x32_bf16 v[72:75], a[104:107], a[8:11], v[72:75]
    ds_read_b64_tr_b16 a[130:131], v36 offset:20480
    v_exp_f32 v67, v67
    v_mfma_f32_16x16x32_bf16 v[72:75], a[108:111], a[12:15], v[72:75]
    ds_read_b64_tr_b16 a[170:171], v37 offset:28672
    v_exp_f32 v68, v68
    v_mfma_f32_16x16x32_bf16 v[76:79], a[112:115], a[0:3], v[48:51]
    buffer_load_dwordx4 v30, s[20:23], s38 offen offset:1024 lds
    v_mfma_f32_16x16x32_bf16 v[76:79], a[116:119], a[4:7], v[76:79]
    ds_read_b64_tr_b16 a[182:183], v38 offset:28680
    v_exp_f32 v70, v70
    v_mfma_f32_16x16x32_bf16 v[76:79], a[120:123], a[8:11], v[76:79]
    ds_read_b64_tr_b16 a[178:179], v38 offset:28672
    v_exp_f32 v69, v69
    v_mfma_f32_16x16x32_bf16 v[76:79], a[124:127], a[12:15], v[76:79]
    ds_read_b64_tr_b16 a[132:133], v36 offset:16392
    v_exp_f32 v66, v66
    v_mfma_f32_16x16x32_bf16 v[80:83], a[64:67], a[16:19], v[52:55]
    ds_read_b64_tr_b16 a[144:145], v38 offset:16384
    v_cvt_pk_bf16_f32 v65, v66, v67
    v_mfma_f32_16x16x32_bf16 v[80:83], a[68:71], a[20:23], v[80:83]
    buffer_load_dwordx4 v30, s[20:23], s38 offen offset:2048 lds
    v_mfma_f32_16x16x32_bf16 v[80:83], a[72:75], a[24:27], v[80:83]
    ds_read_b64_tr_b16 a[180:181], v38 offset:24584
    v_cvt_pk_bf16_f32 v66, v68, v69
    v_mfma_f32_16x16x32_bf16 v[80:83], a[76:79], a[28:31], v[80:83]
    ds_read_b64_tr_b16 a[146:147], v38 offset:20480
    v_exp_f32 v73, v73
    v_mfma_f32_16x16x32_bf16 v[84:87], a[80:83], a[16:19], v[52:55]
    ds_read_b64_tr_b16 a[162:163], v36 offset:28672
    v_exp_f32 v79, v79
    v_mfma_f32_16x16x32_bf16 v[84:87], a[84:87], a[20:23], v[84:87]
    ds_read_b64_tr_b16 a[128:129], v36 offset:16384
    v_exp_f32 v75, v75
    v_mfma_f32_16x16x32_bf16 v[84:87], a[88:91], a[24:27], v[84:87]
    ds_read_b64_tr_b16 a[140:141], v37 offset:16392
    v_exp_f32 v74, v74
    v_mfma_f32_16x16x32_bf16 v[84:87], a[92:95], a[28:31], v[84:87]
    buffer_load_dwordx4 v30, s[20:23], s38 offen offset:3072 lds
    v_exp_f32 v71, v71
    v_mfma_f32_16x16x32_bf16 v[88:91], a[96:99], a[16:19], v[52:55]
    ds_read_b64_tr_b16 a[134:135], v36 offset:20488
    v_exp_f32 v72, v72
    v_exp_f32 v76, v76
    v_mfma_f32_16x16x32_bf16 v[88:91], a[100:103], a[20:23], v[88:91]
    ds_read_b64_tr_b16 a[172:173], v37 offset:24584
    v_cvt_pk_bf16_f32 v68, v72, v73
    v_mfma_f32_16x16x32_bf16 v[88:91], a[104:107], a[24:27], v[88:91]
    ds_read_b64_tr_b16 a[176:177], v38 offset:24576
    v_cvt_pk_bf16_f32 v67, v70, v71
    v_mfma_f32_16x16x32_bf16 v[88:91], a[108:111], a[28:31], v[88:91]
    ds_read_b64_tr_b16 a[184:185], v39 offset:24576
    v_exp_f32 v78, v78
    v_mfma_f32_16x16x32_bf16 v[92:95], a[112:115], a[16:19], v[52:55]
    ds_read_b64_tr_b16 a[150:151], v38 offset:20488
    v_cvt_pk_bf16_f32 v69, v74, v75
    v_cvt_pk_bf16_f32 v71, v78, v79
    v_mfma_f32_16x16x32_bf16 v[92:95], a[116:119], a[20:23], v[92:95]
    ds_read_b64_tr_b16 a[174:175], v37 offset:28680
    v_exp_f32 v77, v77
    v_mfma_f32_16x16x32_bf16 v[92:95], a[120:123], a[24:27], v[92:95]
    ds_read_b64_tr_b16 a[148:149], v38 offset:16392
    v_cvt_pk_bf16_f32 v70, v76, v77
    v_mfma_f32_16x16x32_bf16 v[92:95], a[124:127], a[28:31], v[92:95]
    ds_read_b64_tr_b16 a[188:189], v39 offset:24584
    v_exp_f32 v88, v88
    v_smfmac_f32_16x16x64_bf16 a[192:195], v[20:23], v[64:71], v29
    s_waitcnt lgkmcnt(7)
    ds_read_b64_tr_b16 a[152:153], v39 offset:16384
    v_exp_f32 v80, v80
    v_mfma_f32_16x16x32_bf16 v[128:131], a[128:131], v[64:67], v[128:131]
    ds_read_b64_tr_b16 a[156:157], v39 offset:16392
    v_exp_f32 v89, v89
    v_mfma_f32_16x16x32_bf16 v[128:131], a[160:163], v[68:71], v[128:131]
    ds_read_b64_tr_b16 a[158:159], v39 offset:20488
    v_exp_f32 v81, v81
    v_mfma_f32_16x16x32_bf16 v[132:135], a[132:135], v[64:67], v[132:135]
    ds_read_b64_tr_b16 a[154:155], v39 offset:20480
    v_exp_f32 v91, v91
    v_mfma_f32_16x16x32_bf16 v[132:135], a[164:167], v[68:71], v[132:135]
    ds_read_b64_tr_b16 a[186:187], v39 offset:28672
    v_exp_f32 v93, v93
    v_mfma_f32_16x16x32_bf16 v[136:139], a[136:139], v[64:67], v[136:139]
    s_waitcnt lgkmcnt(6)
    v_exp_f32 v83, v83
    v_mfma_f32_16x16x32_bf16 v[136:139], a[168:171], v[68:71], v[136:139]
    s_waitcnt vmcnt(8)
    v_exp_f32 v82, v82
    v_mfma_f32_16x16x32_bf16 v[140:143], a[140:143], v[64:67], v[140:143]
    ds_read_b128 a[32:35], v16 offset:16384
    v_cvt_pk_bf16_f32 v80, v80, v81
    v_mfma_f32_16x16x32_bf16 v[140:143], a[172:175], v[68:71], v[140:143]
    v_exp_f32 v87, v87
    v_mfma_f32_16x16x32_bf16 v[144:147], a[144:147], v[64:67], v[144:147]
    s_add_u32 m0, s44, 0x24000
    v_exp_f32 v92, v92
    v_mfma_f32_16x16x32_bf16 v[144:147], a[176:179], v[68:71], v[144:147]
    buffer_load_dwordx4 v32, s[12:15], s33 offen offset:0 lds
    v_mfma_f32_16x16x32_bf16 v[148:151], a[148:151], v[64:67], v[148:151]
    ds_read_b128 a[36:39], v17 offset:16384
    v_cvt_pk_bf16_f32 v81, v82, v83
    v_mfma_f32_16x16x32_bf16 v[148:151], a[180:183], v[68:71], v[148:151]
    s_waitcnt lgkmcnt(3)
    ds_read_b128 a[40:43], v18 offset:16384
    v_lshlrev_b32 v7, 4, v0
    v_mfma_f32_16x16x32_bf16 v[152:155], a[152:155], v[64:67], v[152:155]
    s_waitcnt lgkmcnt(3)
    v_exp_f32 v94, v94
    v_mfma_f32_16x16x32_bf16 v[152:155], a[184:187], v[68:71], v[152:155]
    v_exp_f32 v90, v90
    v_mfma_f32_16x16x32_bf16 v[156:159], a[156:159], v[64:67], v[156:159]
    buffer_load_dwordx4 v33, s[12:15], s33 offen offset:1024 lds
    v_mfma_f32_16x16x32_bf16 v[156:159], a[188:191], v[68:71], v[156:159]
    s_waitcnt lgkmcnt(2)
    v_exp_f32 v84, v84
    v_mfma_f32_16x16x32_bf16 v[96:99], a[210:213], a[32:35], 0
    v_exp_f32 v85, v85
    v_mfma_f32_16x16x32_bf16 v[96:99], a[214:217], a[32:35], v[96:99]
    v_exp_f32 v95, v95
    v_mfma_f32_16x16x32_bf16 v[100:103], a[208:211], a[32:35], 0
    ds_read_b128 a[44:47], v19 offset:16384
    v_cvt_pk_bf16_f32 v82, v84, v85
    v_mfma_f32_16x16x32_bf16 v[100:103], a[212:215], a[32:35], v[100:103]
    s_waitcnt lgkmcnt(2)
    buffer_load_dwordx4 v34, s[12:15], s33 offen offset:2048 lds
    v_mfma_f32_16x16x32_bf16 v[104:107], a[210:213], a[36:39], 0
    s_waitcnt lgkmcnt(1)
    v_exp_f32 v86, v86
    v_mfma_f32_16x16x32_bf16 v[104:107], a[214:217], a[36:39], v[104:107]
    v_cvt_pk_bf16_f32 v13, v98, v99
    v_accvgpr_write_b32 a33, v13
    v_mfma_f32_16x16x32_bf16 v[108:111], a[208:211], a[36:39], 0
    v_cvt_pk_bf16_f32 v83, v86, v87
    v_cvt_pk_bf16_f32 v12, v96, v97
    v_mfma_f32_16x16x32_bf16 v[108:111], a[212:215], a[36:39], v[108:111]
    v_accvgpr_write_b32 a32, v12
    v_cvt_pk_bf16_f32 v14, v100, v101
    v_mfma_f32_16x16x32_bf16 v[96:99], a[210:213], a[40:43], 0
    buffer_load_dwordx4 v35, s[12:15], s33 offen offset:3072 lds
    v_mfma_f32_16x16x32_bf16 v[96:99], a[214:217], a[40:43], v[96:99]
    v_cvt_pk_bf16_f32 v15, v102, v103
    v_cvt_pk_bf16_f32 v8, v104, v105
    v_mfma_f32_16x16x32_bf16 v[100:103], a[208:211], a[40:43], 0
    v_cvt_pk_bf16_f32 v9, v106, v107
    v_accvgpr_write_b32 a37, v9
    v_mfma_f32_16x16x32_bf16 v[100:103], a[212:215], a[40:43], v[100:103]
    s_waitcnt lgkmcnt(0)
    v_accvgpr_write_b32 a34, v14
    v_cvt_pk_bf16_f32 v10, v108, v109
    v_mfma_f32_16x16x32_bf16 v[104:107], a[210:213], a[44:47], 0
    v_accvgpr_write_b32 a35, v15
    v_cvt_pk_bf16_f32 v11, v110, v111
    v_mfma_f32_16x16x32_bf16 v[104:107], a[214:217], a[44:47], v[104:107]
    v_cvt_pk_bf16_f32 v12, v96, v97
    v_cvt_pk_bf16_f32 v13, v98, v99
    v_mfma_f32_16x16x32_bf16 v[108:111], a[208:211], a[44:47], 0
    v_accvgpr_write_b32 a36, v8
    v_accvgpr_write_b32 a39, v11
    v_mfma_f32_16x16x32_bf16 v[108:111], a[212:215], a[44:47], v[108:111]
    v_accvgpr_write_b32 a38, v10
    v_cvt_pk_bf16_f32 v14, v100, v101
    v_accvgpr_write_b32 a42, v14
    v_mfma_f32_16x16x32_bf16 v[96:99], a[64:67], a[32:35], 0
    v_accvgpr_write_b32 a41, v13
    v_cvt_pk_bf16_f32 v15, v102, v103
    v_mfma_f32_16x16x32_bf16 v[96:99], a[68:71], a[36:39], v[96:99]
    v_cvt_pk_bf16_f32 v8, v104, v105
    v_cvt_pk_bf16_f32 v9, v106, v107
    v_mfma_f32_16x16x32_bf16 v[100:103], a[80:83], a[32:35], 0
    v_accvgpr_write_b32 a40, v12
    v_accvgpr_write_b32 a43, v15
    v_mfma_f32_16x16x32_bf16 v[100:103], a[84:87], a[36:39], v[100:103]
    v_cvt_pk_bf16_f32 v11, v110, v111
    v_accvgpr_write_b32 a47, v11
    v_mfma_f32_16x16x32_bf16 v[96:99], a[72:75], a[40:43], v[96:99]
    v_accvgpr_write_b32 a44, v8
    v_accvgpr_write_b32 a45, v9
    v_cvt_pk_bf16_f32 v10, v108, v109
    v_accvgpr_write_b32 a46, v10
    v_mfma_f32_16x16x32_bf16 v[100:103], a[88:91], a[40:43], v[100:103]
    v_cvt_pk_bf16_f32 v84, v88, v89
    v_cvt_pk_bf16_f32 v85, v90, v91
    v_mfma_f32_16x16x32_bf16 v[96:99], a[76:79], a[44:47], v[96:99]
    v_cvt_pk_bf16_f32 v86, v92, v93
    v_cvt_pk_bf16_f32 v87, v94, v95
    v_mfma_f32_16x16x32_bf16 v[100:103], a[92:95], a[44:47], v[100:103]
    s_nop 0
    v_smfmac_f32_16x16x64_bf16 a[196:199], v[20:23], v[80:87], v29
    v_mfma_f32_16x16x32_bf16 v[160:163], a[128:131], v[80:83], v[160:163]
    s_nop 0
    v_mfma_f32_16x16x32_bf16 v[160:163], a[160:163], v[84:87], v[160:163]
    v_max3_f32 v12, v96, v97, v98
    v_max3_f32 v12, v12, v99, v26
    v_mov_b32 v13, v12
    v_mfma_f32_16x16x32_bf16 v[164:167], a[132:135], v[80:83], v[164:167]
    v_mfma_f32_16x16x32_bf16 v[164:167], a[164:167], v[84:87], v[164:167]
    s_waitcnt vmcnt(8)
    v_permlane16_swap_b32 v12, v13
    v_max_f32 v12, v12, v13
    v_mov_b32 v13, v12
    v_mfma_f32_16x16x32_bf16 v[168:171], a[136:139], v[80:83], v[168:171]
    s_add_u32 m0, s44, 0xc000
    v_permlane32_swap_b32 v12, v13
    v_min_f32 v59, -v12, -v13
    v_mfma_f32_16x16x32_bf16 v[168:171], a[168:171], v[84:87], v[168:171]
    v_min_f32 v56, -v12, -v13
    v_min_f32 v57, -v12, -v13
    v_min_f32 v58, -v12, -v13
    v_mfma_f32_16x16x32_bf16 v[172:175], a[140:143], v[80:83], v[172:175]
    buffer_load_dwordx4 v32, s[16:19], s39 offen offset:0 lds
    v_add_f32 v97, v97, v57
    v_mfma_f32_16x16x32_bf16 v[104:107], a[96:99], a[32:35], v[56:59]
    v_exp_f32 v97, v97
    v_mfma_f32_16x16x32_bf16 v[104:107], a[100:103], a[36:39], v[104:107]
    v_add_f32 v102, v102, v58
    v_add_f32 v103, v103, v59
    v_mfma_f32_16x16x32_bf16 v[104:107], a[104:107], a[40:43], v[104:107]
    v_exp_f32 v102, v102
    v_mfma_f32_16x16x32_bf16 v[104:107], a[108:111], a[44:47], v[104:107]
    v_add_f32 v96, v96, v56
    v_exp_f32 v96, v96
    v_add_f32 v98, v98, v58
    v_mfma_f32_16x16x32_bf16 v[108:111], a[112:115], a[32:35], v[56:59]
    buffer_load_dwordx4 v33, s[16:19], s39 offen offset:1024 lds
    v_add_f32 v101, v101, v57
    v_mfma_f32_16x16x32_bf16 v[108:111], a[116:119], a[36:39], v[108:111]
    v_exp_f32 v101, v101
    v_mfma_f32_16x16x32_bf16 v[108:111], a[120:123], a[40:43], v[108:111]
    v_exp_f32 v98, v98
    v_add_f32 v100, v100, v56
    v_mfma_f32_16x16x32_bf16 v[108:111], a[124:127], a[44:47], v[108:111]
    v_add_f32 v99, v99, v59
    v_cvt_pk_bf16_f32 v96, v96, v97
    v_mfma_f32_16x16x32_bf16 v[172:175], a[172:175], v[84:87], v[172:175]
    v_exp_f32 v107, v107
    v_mfma_f32_16x16x32_bf16 v[176:179], a[144:147], v[80:83], v[176:179]
    buffer_load_dwordx4 v34, s[16:19], s39 offen offset:2048 lds
    v_exp_f32 v103, v103
    v_mfma_f32_16x16x32_bf16 v[176:179], a[176:179], v[84:87], v[176:179]
    v_exp_f32 v100, v100
    v_exp_f32 v106, v106
    v_mfma_f32_16x16x32_bf16 v[180:183], a[148:151], v[80:83], v[180:183]
    v_exp_f32 v99, v99
    v_exp_f32 v111, v111
    v_mfma_f32_16x16x32_bf16 v[180:183], a[180:183], v[84:87], v[180:183]
    v_exp_f32 v110, v110
    v_mfma_f32_16x16x32_bf16 v[184:187], a[152:155], v[80:83], v[184:187]
    v_exp_f32 v109, v109
    v_mfma_f32_16x16x32_bf16 v[184:187], a[184:187], v[84:87], v[184:187]
    v_cvt_pk_bf16_f32 v97, v98, v99
    v_cvt_pk_bf16_f32 v98, v100, v101
    v_exp_f32 v104, v104
    v_exp_f32 v105, v105
    v_exp_f32 v108, v108
    v_cvt_pk_bf16_f32 v101, v106, v107
    v_mfma_f32_16x16x32_bf16 v[188:191], a[156:159], v[80:83], v[188:191]
    v_cvt_pk_bf16_f32 v99, v102, v103
    v_cvt_pk_bf16_f32 v100, v104, v105
    v_cvt_pk_bf16_f32 v102, v108, v109
    v_cvt_pk_bf16_f32 v103, v110, v111
    v_mfma_f32_16x16x32_bf16 v[188:191], a[188:191], v[84:87], v[188:191]
    s_barrier
    v_smfmac_f32_16x16x64_bf16 a[200:203], v[20:23], v[96:103], v29
    ds_read_b128 a[124:127], v47 offset:45056
    v_mfma_f32_16x16x32_bf16 v[192:195], a[128:131], v[96:99], 0
    buffer_load_dwordx4 v35, s[16:19], s39 offen offset:3072 lds
    v_mfma_f32_16x16x32_bf16 v[192:195], a[160:163], v[100:103], v[192:195]
    ds_read_b128 a[112:115], v44 offset:45056
    v_mfma_f32_16x16x32_bf16 v[196:199], a[132:135], v[96:99], 0
    ds_read_b128 a[116:119], v45 offset:45056
    v_mfma_f32_16x16x32_bf16 v[196:199], a[164:167], v[100:103], v[196:199]
    ds_read_b128 a[68:71], v45 offset:32768
    ds_read_b128 a[72:75], v46 offset:32768
    v_mfma_f32_16x16x32_bf16 v[200:203], a[136:139], v[96:99], 0
    ds_read_b128 a[64:67], v44 offset:32768
    v_mfma_f32_16x16x32_bf16 v[200:203], a[168:171], v[100:103], v[200:203]
    ds_read_b128 a[88:91], v46 offset:36864
    ds_read_b128 a[92:95], v47 offset:36864
    v_mfma_f32_16x16x32_bf16 v[204:207], a[140:143], v[96:99], 0
    ds_read_b128 a[76:79], v47 offset:32768
    v_mfma_f32_16x16x32_bf16 v[204:207], a[172:175], v[100:103], v[204:207]
    ds_read_b128 a[80:83], v44 offset:36864
    v_mfma_f32_16x16x32_bf16 v[208:211], a[144:147], v[96:99], 0
    ds_read_b128 a[84:87], v45 offset:36864
    ds_read_b128 a[120:123], v46 offset:45056
    v_mfma_f32_16x16x32_bf16 v[208:211], a[176:179], v[100:103], v[208:211]
    ds_read_b128 a[104:107], v46 offset:40960
    v_mfma_f32_16x16x32_bf16 v[212:215], a[148:151], v[96:99], 0
    s_waitcnt vmcnt(8)
    ds_read_b128 a[108:111], v47 offset:40960
    v_mfma_f32_16x16x32_bf16 v[212:215], a[180:183], v[100:103], v[212:215]
    ds_read_b128 a[100:103], v45 offset:40960
    v_mfma_f32_16x16x32_bf16 v[216:219], a[152:155], v[96:99], 0
    s_barrier
    v_mfma_f32_16x16x32_bf16 v[216:219], a[184:187], v[100:103], v[216:219]
    ds_read_b64_tr_b16 a[186:187], v39 offset:45056
    v_mfma_f32_16x16x32_bf16 v[220:223], a[156:159], v[96:99], 0
    s_add_u32 s54, s52, L_s3-L_pc-1024
    ds_read_b128 a[96:99], v44 offset:40960
    v_mfma_f32_16x16x32_bf16 v[220:223], a[188:191], v[100:103], v[220:223]
L_s2:
    s_waitcnt lgkmcnt(8)
    s_addc_u32 s55, s53, 0
    ds_read_b64_tr_b16 a[168:169], v37 offset:40960
    v_mfma_f32_16x16x32_bf16 v[64:67], a[64:67], a[0:3], v[48:51]
    ds_read_b64_tr_b16 a[132:133], v36 offset:32776
    ds_read_b64_tr_b16 a[172:173], v37 offset:40968
L_pg1:
    s_cbranch_execz L_pgret1
    v_mfma_f32_16x16x32_bf16 v[64:67], a[68:71], a[4:7], v[64:67]
    ds_read_b64_tr_b16 a[160:161], v36 offset:40960
    ds_read_b64_tr_b16 a[150:151], v38 offset:36872
    v_mfma_f32_16x16x32_bf16 v[64:67], a[72:75], a[8:11], v[64:67]
    global_load_dwordx4 v[40:43], v7, s[54:55]
    v_mfma_f32_16x16x32_bf16 v[64:67], a[76:79], a[12:15], v[64:67]
    s_waitcnt lgkmcnt(7)
    ds_read_b64_tr_b16 a[142:143], v37 offset:36872
    v_mfma_f32_16x16x32_bf16 v[68:71], a[80:83], a[0:3], v[48:51]
    ds_read_b64_tr_b16 a[164:165], v36 offset:40968
    v_mfma_f32_16x16x32_bf16 v[68:71], a[84:87], a[4:7], v[68:71]
    ds_read_b64_tr_b16 a[140:141], v37 offset:32776
    ds_read_b64_tr_b16 a[144:145], v38 offset:32768
    v_mfma_f32_16x16x32_bf16 v[68:71], a[88:91], a[8:11], v[68:71]
    ds_read_b64_tr_b16 a[180:181], v38 offset:40968
    v_mfma_f32_16x16x32_bf16 v[68:71], a[92:95], a[12:15], v[68:71]
    s_waitcnt lgkmcnt(10)
    ds_read_b64_tr_b16 a[128:129], v36 offset:32768
    v_exp_f32 v64, v64
    v_mfma_f32_16x16x32_bf16 v[72:75], a[96:99], a[0:3], v[48:51]
    v_exp_f32 v67, v67
    v_mfma_f32_16x16x32_bf16 v[72:75], a[100:103], a[4:7], v[72:75]
    ds_read_b64_tr_b16 a[138:139], v37 offset:36864
    ds_read_b64_tr_b16 a[156:157], v39 offset:32776
    v_mfma_f32_16x16x32_bf16 v[72:75], a[104:107], a[8:11], v[72:75]
    s_add_u32 m0, s44, 0x1c000
    v_exp_f32 v65, v65
    v_mfma_f32_16x16x32_bf16 v[72:75], a[108:111], a[12:15], v[72:75]
    buffer_load_dwordx4 v30, s[20:23], s39 offen offset:0 lds
    v_mfma_f32_16x16x32_bf16 v[76:79], a[112:115], a[0:3], v[48:51]
    ds_read_b64_tr_b16 a[148:149], v38 offset:32776
    v_exp_f32 v71, v71
    v_mfma_f32_16x16x32_bf16 v[76:79], a[116:119], a[4:7], v[76:79]
    v_exp_f32 v70, v70
    v_mfma_f32_16x16x32_bf16 v[76:79], a[120:123], a[8:11], v[76:79]
    ds_read_b64_tr_b16 a[146:147], v38 offset:36864
    v_cvt_pk_bf16_f32 v64, v64, v65
    v_mfma_f32_16x16x32_bf16 v[76:79], a[124:127], a[12:15], v[76:79]
    v_exp_f32 v69, v69
    v_mfma_f32_16x16x32_bf16 v[80:83], a[64:67], a[16:19], v[52:55]
    v_exp_f32 v75, v75
    v_mfma_f32_16x16x32_bf16 v[80:83], a[68:71], a[20:23], v[80:83]
    buffer_load_dwordx4 v30, s[20:23], s39 offen offset:1024 lds
    v_mfma_f32_16x16x32_bf16 v[80:83], a[72:75], a[24:27], v[80:83]
    ds_read_b64_tr_b16 a[166:167], v36 offset:45064
    ds_read_b64_tr_b16 a[174:175], v37 offset:45064
    v_mfma_f32_16x16x32_bf16 v[80:83], a[76:79], a[28:31], v[80:83]
    v_exp_f32 v76, v76
    v_mfma_f32_16x16x32_bf16 v[84:87], a[80:83], a[16:19], v[52:55]
    v_exp_f32 v66, v66
    v_mfma_f32_16x16x32_bf16 v[84:87], a[84:87], a[20:23], v[84:87]
    v_exp_f32 v74, v74
    v_mfma_f32_16x16x32_bf16 v[84:87], a[88:91], a[24:27], v[84:87]
    buffer_load_dwordx4 v30, s[20:23], s39 offen offset:2048 lds
    v_mfma_f32_16x16x32_bf16 v[84:87], a[92:95], a[28:31], v[84:87]
    ds_read_b64_tr_b16 a[152:153], v39 offset:32768
    v_cvt_pk_bf16_f32 v65, v66, v67
    v_mfma_f32_16x16x32_bf16 v[88:91], a[96:99], a[16:19], v[52:55]
    ds_read_b64_tr_b16 a[182:183], v38 offset:45064
    v_exp_f32 v68, v68
    v_mfma_f32_16x16x32_bf16 v[88:91], a[100:103], a[20:23], v[88:91]
    ds_read_b64_tr_b16 a[176:177], v38 offset:40960
    v_cvt_pk_bf16_f32 v66, v68, v69
    v_mfma_f32_16x16x32_bf16 v[88:91], a[104:107], a[24:27], v[88:91]
    v_exp_f32 v81, v81
    v_mfma_f32_16x16x32_bf16 v[88:91], a[108:111], a[28:31], v[88:91]
    buffer_load_dwordx4 v30, s[20:23], s39 offen offset:3072 lds
    v_mfma_f32_16x16x32_bf16 v[92:95], a[112:115], a[16:19], v[52:55]
    ds_read_b64_tr_b16 a[130:131], v36 offset:36864
    v_cvt_pk_bf16_f32 v69, v74, v75
    v_mfma_f32_16x16x32_bf16 v[92:95], a[116:119], a[20:23], v[92:95]
    s_add_u32 m0, s44, 0x0
    v_exp_f32 v80, v80
    v_mfma_f32_16x16x32_bf16 v[92:95], a[120:123], a[24:27], v[92:95]
    v_exp_f32 v72, v72
    v_mfma_f32_16x16x32_bf16 v[92:95], a[124:127], a[28:31], v[92:95]
    ds_read_b64_tr_b16 a[188:189], v39 offset:40968
    v_cvt_pk_bf16_f32 v67, v70, v71
    v_mfma_f32_16x16x32_bf16 v[96:99], a[64:67], a[32:35], v[56:59]
    buffer_load_dwordx4 v32, s[16:19], s40 offen offset:0 lds
    v_mfma_f32_16x16x32_bf16 v[96:99], a[68:71], a[36:39], v[96:99]
    ds_read_b64_tr_b16 a[136:137], v37 offset:32768
    v_exp_f32 v73, v73
    v_mfma_f32_16x16x32_bf16 v[96:99], a[72:75], a[40:43], v[96:99]
    v_exp_f32 v85, v85
    v_mfma_f32_16x16x32_bf16 v[96:99], a[76:79], a[44:47], v[96:99]
    v_exp_f32 v82, v82
    v_mfma_f32_16x16x32_bf16 v[100:103], a[80:83], a[32:35], v[56:59]
    v_exp_f32 v86, v86
    v_mfma_f32_16x16x32_bf16 v[100:103], a[84:87], a[36:39], v[100:103]
    buffer_load_dwordx4 v33, s[16:19], s40 offen offset:1024 lds
    v_mfma_f32_16x16x32_bf16 v[100:103], a[88:91], a[40:43], v[100:103]
    v_exp_f32 v77, v77
    v_mfma_f32_16x16x32_bf16 v[100:103], a[92:95], a[44:47], v[100:103]
    ds_read_b64_tr_b16 a[154:155], v39 offset:36864
    v_cvt_pk_bf16_f32 v68, v72, v73
    v_mfma_f32_16x16x32_bf16 v[104:107], a[96:99], a[32:35], v[56:59]
    ds_read_b64_tr_b16 a[162:163], v36 offset:45056
    v_exp_f32 v79, v79
    v_mfma_f32_16x16x32_bf16 v[104:107], a[100:103], a[36:39], v[104:107]
    ds_read_b64_tr_b16 a[134:135], v36 offset:36872
    v_cvt_pk_bf16_f32 v70, v76, v77
    v_mfma_f32_16x16x32_bf16 v[104:107], a[104:107], a[40:43], v[104:107]
    buffer_load_dwordx4 v34, s[16:19], s40 offen offset:2048 lds
    v_mfma_f32_16x16x32_bf16 v[104:107], a[108:111], a[44:47], v[104:107]
    v_exp_f32 v94, v94
    v_mfma_f32_16x16x32_bf16 v[108:111], a[112:115], a[32:35], v[56:59]
    ds_read_b64_tr_b16 a[170:171], v37 offset:45056
    v_exp_f32 v78, v78
    v_mfma_f32_16x16x32_bf16 v[108:111], a[116:119], a[36:39], v[108:111]
    s_waitcnt lgkmcnt(4)
    v_exp_f32 v93, v93
    v_mfma_f32_16x16x32_bf16 v[108:111], a[120:123], a[40:43], v[108:111]
    ds_read_b64_tr_b16 a[178:179], v38 offset:45056
    v_cvt_pk_bf16_f32 v71, v78, v79
    v_mfma_f32_16x16x32_bf16 v[108:111], a[124:127], a[44:47], v[108:111]
    buffer_load_dwordx4 v35, s[16:19], s40 offen offset:3072 lds
    v_smfmac_f32_16x16x64_bf16 a[192:195], v[20:23], v[64:71], v29
    ds_read_b64_tr_b16 a[184:185], v39 offset:40960
    v_exp_f32 v88, v88
    v_mfma_f32_16x16x32_bf16 v[128:131], a[128:131], v[64:67], v[128:131]
    s_waitcnt lgkmcnt(4)
    v_exp_f32 v103, v103
    v_mfma_f32_16x16x32_bf16 v[128:131], a[160:163], v[68:71], v[128:131]
    s_waitcnt lgkmcnt(3)
    ds_read_b64_tr_b16 a[190:191], v39 offset:45064
    v_cvt_pk_bf16_f32 v80, v80, v81
    v_mfma_f32_16x16x32_bf16 v[132:135], a[132:135], v[64:67], v[132:135]
    v_exp_f32 v83, v83
    v_mfma_f32_16x16x32_bf16 v[132:135], a[164:167], v[68:71], v[132:135]
    s_waitcnt lgkmcnt(3)
    v_exp_f32 v95, v95
    v_mfma_f32_16x16x32_bf16 v[136:139], a[136:139], v[64:67], v[136:139]
    ds_read_b64_tr_b16 a[158:159], v39 offset:36872
    v_cvt_pk_bf16_f32 v81, v82, v83
    v_mfma_f32_16x16x32_bf16 v[136:139], a[168:171], v[68:71], v[136:139]
    s_add_u32 m0, s44, 0x10000
    v_exp_f32 v87, v87
    v_mfma_f32_16x16x32_bf16 v[140:143], a[140:143], v[64:67], v[140:143]
    buffer_load_dwordx4 v30, s[20:23], s40 offen offset:0 lds
    v_mfma_f32_16x16x32_bf16 v[140:143], a[172:175], v[68:71], v[140:143]
    s_waitcnt lgkmcnt(3)
    v_exp_f32 v84, v84
    v_mfma_f32_16x16x32_bf16 v[144:147], a[144:147], v[64:67], v[144:147]
    v_cvt_pk_bf16_f32 v82, v84, v85
    v_cvt_pk_bf16_f32 v83, v86, v87
    v_mfma_f32_16x16x32_bf16 v[144:147], a[176:179], v[68:71], v[144:147]
    s_waitcnt lgkmcnt(2)
    v_exp_f32 v90, v90
    v_mfma_f32_16x16x32_bf16 v[148:151], a[148:151], v[64:67], v[148:151]
    v_exp_f32 v89, v89
    v_mfma_f32_16x16x32_bf16 v[148:151], a[180:183], v[68:71], v[148:151]
    s_waitcnt lgkmcnt(1)
    v_cvt_pk_bf16_f32 v84, v88, v89
    v_cvt_pk_bf16_f32 v87, v94, v95
    v_mfma_f32_16x16x32_bf16 v[152:155], a[152:155], v[64:67], v[152:155]
    v_exp_f32 v91, v91
    v_mfma_f32_16x16x32_bf16 v[152:155], a[184:187], v[68:71], v[152:155]
    s_waitcnt lgkmcnt(0)
    v_exp_f32 v92, v92
    v_mfma_f32_16x16x32_bf16 v[156:159], a[156:159], v[64:67], v[156:159]
    v_cvt_pk_bf16_f32 v85, v90, v91
    v_cvt_pk_bf16_f32 v86, v92, v93
    v_mfma_f32_16x16x32_bf16 v[156:159], a[188:191], v[68:71], v[156:159]
    v_exp_f32 v105, v105
    v_smfmac_f32_16x16x64_bf16 a[196:199], v[20:23], v[80:87], v29
    buffer_load_dwordx4 v30, s[20:23], s40 offen offset:1024 lds
    v_mfma_f32_16x16x32_bf16 v[160:163], a[128:131], v[80:83], v[160:163]
    v_exp_f32 v107, v107
    v_mfma_f32_16x16x32_bf16 v[160:163], a[160:163], v[84:87], v[160:163]
    v_exp_f32 v97, v97
    v_mfma_f32_16x16x32_bf16 v[164:167], a[132:135], v[80:83], v[164:167]
    v_exp_f32 v96, v96
    v_mfma_f32_16x16x32_bf16 v[164:167], a[164:167], v[84:87], v[164:167]
    v_exp_f32 v98, v98
    v_mfma_f32_16x16x32_bf16 v[168:171], a[136:139], v[80:83], v[168:171]
    v_exp_f32 v101, v101
    v_mfma_f32_16x16x32_bf16 v[168:171], a[168:171], v[84:87], v[168:171]
    s_waitcnt vmcnt(15)
    ds_read_b128 a[48:51], v16 offset:49152
    v_mfma_f32_16x16x32_bf16 v[172:175], a[140:143], v[80:83], v[172:175]
    v_exp_f32 v100, v100
    v_mfma_f32_16x16x32_bf16 v[172:175], a[172:175], v[84:87], v[172:175]
    ds_read_b128 a[52:55], v17 offset:49152
    v_mfma_f32_16x16x32_bf16 v[176:179], a[144:147], v[80:83], v[176:179]
    buffer_load_dwordx4 v30, s[20:23], s40 offen offset:2048 lds
    v_mfma_f32_16x16x32_bf16 v[176:179], a[176:179], v[84:87], v[176:179]
    v_exp_f32 v106, v106
    v_mfma_f32_16x16x32_bf16 v[180:183], a[148:151], v[80:83], v[180:183]
    v_exp_f32 v99, v99
    v_mfma_f32_16x16x32_bf16 v[180:183], a[180:183], v[84:87], v[180:183]
    v_exp_f32 v110, v110
    v_mfma_f32_16x16x32_bf16 v[184:187], a[152:155], v[80:83], v[184:187]
    ds_read_b128 a[56:59], v18 offset:49152
    v_cvt_pk_bf16_f32 v96, v96, v97
    v_mfma_f32_16x16x32_bf16 v[184:187], a[184:187], v[84:87], v[184:187]
    ds_read_b128 a[60:63], v19 offset:49152
    v_cvt_pk_bf16_f32 v97, v98, v99
    v_mfma_f32_16x16x32_bf16 v[188:191], a[156:159], v[80:83], v[188:191]
    s_waitcnt lgkmcnt(3)
    v_exp_f32 v111, v111
    v_mfma_f32_16x16x32_bf16 v[188:191], a[188:191], v[84:87], v[188:191]
    v_exp_f32 v102, v102
    v_mfma_f32_16x16x32_bf16 v[112:115], a[210:213], a[48:51], 0
    s_waitcnt lgkmcnt(2)
    v_cvt_pk_bf16_f32 v99, v102, v103
    v_cvt_pk_bf16_f32 v103, v110, v111
    v_mfma_f32_16x16x32_bf16 v[112:115], a[214:217], a[48:51], v[112:115]
    buffer_load_dwordx4 v30, s[20:23], s40 offen offset:3072 lds
    v_mfma_f32_16x16x32_bf16 v[116:119], a[208:211], a[48:51], 0
    v_cvt_pk_bf16_f32 v98, v100, v101
    v_cvt_pk_bf16_f32 v101, v106, v107
    v_mfma_f32_16x16x32_bf16 v[116:119], a[212:215], a[48:51], v[116:119]
    v_exp_f32 v104, v104
    v_mfma_f32_16x16x32_bf16 v[120:123], a[210:213], a[52:55], 0
    v_exp_f32 v109, v109
    v_mfma_f32_16x16x32_bf16 v[120:123], a[214:217], a[52:55], v[120:123]
    s_waitcnt lgkmcnt(1)
    v_cvt_pk_bf16_f32 v15, v114, v115
    v_accvgpr_write_b32 a49, v15
    v_mfma_f32_16x16x32_bf16 v[124:127], a[208:211], a[52:55], 0
    v_cvt_pk_bf16_f32 v14, v112, v113
    v_accvgpr_write_b32 a48, v14
    v_mfma_f32_16x16x32_bf16 v[124:127], a[212:215], a[52:55], v[124:127]
    v_cvt_pk_bf16_f32 v8, v116, v117
    v_cvt_pk_bf16_f32 v9, v118, v119
    v_mfma_f32_16x16x32_bf16 v[112:115], a[210:213], a[56:59], 0
    s_add_u32 m0, s44, 0x4000
    v_accvgpr_write_b32 a50, v8
    v_accvgpr_write_b32 a51, v9
    v_mfma_f32_16x16x32_bf16 v[112:115], a[214:217], a[56:59], v[112:115]
    s_waitcnt lgkmcnt(0)
    v_cvt_pk_bf16_f32 v10, v120, v121
    v_cvt_pk_bf16_f32 v11, v122, v123
    v_mfma_f32_16x16x32_bf16 v[116:119], a[208:211], a[56:59], 0
    buffer_load_dwordx4 v32, s[16:19], s41 offen offset:0 lds
    v_mfma_f32_16x16x32_bf16 v[116:119], a[212:215], a[56:59], v[116:119]
    v_cvt_pk_bf16_f32 v12, v124, v125
    v_cvt_pk_bf16_f32 v13, v126, v127
    v_mfma_f32_16x16x32_bf16 v[120:123], a[210:213], a[60:63], 0
    v_accvgpr_write_b32 a53, v11
    v_accvgpr_write_b32 a54, v12
    v_mfma_f32_16x16x32_bf16 v[120:123], a[214:217], a[60:63], v[120:123]
    v_accvgpr_write_b32 a52, v10
    v_cvt_pk_bf16_f32 v15, v114, v115
    v_mfma_f32_16x16x32_bf16 v[124:127], a[208:211], a[60:63], 0
    v_accvgpr_write_b32 a55, v13
    v_cvt_pk_bf16_f32 v14, v112, v113
    v_mfma_f32_16x16x32_bf16 v[124:127], a[212:215], a[60:63], v[124:127]
    v_accvgpr_write_b32 a56, v14
    v_cvt_pk_bf16_f32 v9, v118, v119
    v_mfma_f32_16x16x32_bf16 v[112:115], a[64:67], a[48:51], 0
    buffer_load_dwordx4 v33, s[16:19], s41 offen offset:1024 lds
    v_accvgpr_write_b32 a57, v15
    v_mfma_f32_16x16x32_bf16 v[112:115], a[68:71], a[52:55], v[112:115]
    v_cvt_pk_bf16_f32 v8, v116, v117
    v_cvt_pk_bf16_f32 v10, v120, v121
    v_mfma_f32_16x16x32_bf16 v[116:119], a[80:83], a[48:51], 0
    v_accvgpr_write_b32 a58, v8
    v_accvgpr_write_b32 a59, v9
    v_accvgpr_write_b32 a60, v10
    v_cvt_pk_bf16_f32 v11, v122, v123
    v_accvgpr_write_b32 a61, v11
    v_mfma_f32_16x16x32_bf16 v[116:119], a[84:87], a[52:55], v[116:119]
    v_cvt_pk_bf16_f32 v13, v126, v127
    v_accvgpr_write_b32 a63, v13
    v_mfma_f32_16x16x32_bf16 v[112:115], a[72:75], a[56:59], v[112:115]
    v_cvt_pk_bf16_f32 v12, v124, v125
    v_accvgpr_write_b32 a62, v12
    v_mfma_f32_16x16x32_bf16 v[116:119], a[88:91], a[56:59], v[116:119]
    v_exp_f32 v108, v108
    v_mfma_f32_16x16x32_bf16 v[112:115], a[76:79], a[60:63], v[112:115]
    v_cvt_pk_bf16_f32 v100, v104, v105
    v_cvt_pk_bf16_f32 v102, v108, v109
    v_mfma_f32_16x16x32_bf16 v[116:119], a[92:95], a[60:63], v[116:119]
    s_nop 0
    v_smfmac_f32_16x16x64_bf16 a[200:203], v[20:23], v[96:103], v29
    v_mfma_f32_16x16x32_bf16 v[192:195], a[128:131], v[96:99], v[192:195]
    buffer_load_dwordx4 v34, s[16:19], s41 offen offset:2048 lds
    v_mfma_f32_16x16x32_bf16 v[192:195], a[160:163], v[100:103], v[192:195]
    v_max3_f32 v14, v112, v113, v114
    v_max3_f32 v14, v14, v115, v27
    v_mov_b32 v15, v14
    v_mfma_f32_16x16x32_bf16 v[196:199], a[132:135], v[96:99], v[196:199]
    v_mfma_f32_16x16x32_bf16 v[196:199], a[164:167], v[100:103], v[196:199]
    v_permlane16_swap_b32 v14, v15
    v_max_f32 v14, v14, v15
    v_mov_b32 v15, v14
    v_mfma_f32_16x16x32_bf16 v[200:203], a[136:139], v[96:99], v[200:203]
    v_mfma_f32_16x16x32_bf16 v[200:203], a[168:171], v[100:103], v[200:203]
    v_permlane32_swap_b32 v14, v15
    v_min_f32 v60, -v14, -v15
    v_min_f32 v63, -v14, -v15
    v_add_f32 v112, v112, v60
    v_add_f32 v116, v116, v60
    v_min_f32 v61, -v14, -v15
    v_min_f32 v62, -v14, -v15
    v_mfma_f32_16x16x32_bf16 v[204:207], a[140:143], v[96:99], v[204:207]
    s_waitcnt vmcnt(16)
    v_add_f32 v113, v113, v61
    v_add_f32 v119, v119, v63
    v_mfma_f32_16x16x32_bf16 v[120:123], a[96:99], a[48:51], v[60:63]
    v_exp_f32 v116, v116
    v_mfma_f32_16x16x32_bf16 v[120:123], a[100:103], a[52:55], v[120:123]
    v_add_f32 v117, v117, v61
    v_exp_f32 v119, v119
    v_mfma_f32_16x16x32_bf16 v[120:123], a[104:107], a[56:59], v[120:123]
    v_exp_f32 v117, v117
    v_mfma_f32_16x16x32_bf16 v[120:123], a[108:111], a[60:63], v[120:123]
    buffer_load_dwordx4 v35, s[16:19], s41 offen offset:3072 lds
    v_add_f32 v114, v114, v62
    v_mfma_f32_16x16x32_bf16 v[124:127], a[112:115], a[48:51], v[60:63]
    v_exp_f32 v114, v114
    v_add_f32 v115, v115, v63
    v_mfma_f32_16x16x32_bf16 v[124:127], a[116:119], a[52:55], v[124:127]
    v_exp_f32 v112, v112
    v_exp_f32 v113, v113
    v_mfma_f32_16x16x32_bf16 v[124:127], a[120:123], a[56:59], v[124:127]
    v_exp_f32 v115, v115
    v_mfma_f32_16x16x32_bf16 v[124:127], a[124:127], a[60:63], v[124:127]
    v_add_f32 v118, v118, v62
    v_exp_f32 v123, v123
    v_mfma_f32_16x16x32_bf16 v[204:207], a[172:175], v[100:103], v[204:207]
    v_exp_f32 v118, v118
    v_exp_f32 v121, v121
    v_mfma_f32_16x16x32_bf16 v[208:211], a[144:147], v[96:99], v[208:211]
    v_cvt_pk_bf16_f32 v112, v112, v113
    v_cvt_pk_bf16_f32 v113, v114, v115
    v_mfma_f32_16x16x32_bf16 v[208:211], a[176:179], v[100:103], v[208:211]
    v_exp_f32 v122, v122
    v_mfma_f32_16x16x32_bf16 v[212:215], a[148:151], v[96:99], v[212:215]
    v_cvt_pk_bf16_f32 v114, v116, v117
    v_exp_f32 v126, v126
    v_mfma_f32_16x16x32_bf16 v[212:215], a[180:183], v[100:103], v[212:215]
    v_cvt_pk_bf16_f32 v115, v118, v119
    v_exp_f32 v124, v124
    v_mfma_f32_16x16x32_bf16 v[216:219], a[152:155], v[96:99], v[216:219]
    v_exp_f32 v120, v120
    v_exp_f32 v125, v125
    v_mfma_f32_16x16x32_bf16 v[216:219], a[184:187], v[100:103], v[216:219]
    v_exp_f32 v127, v127
    v_cvt_pk_bf16_f32 v116, v120, v121
    v_cvt_pk_bf16_f32 v118, v124, v125
    v_mfma_f32_16x16x32_bf16 v[220:223], a[156:159], v[96:99], v[220:223]
    v_cvt_pk_bf16_f32 v117, v122, v123
    v_cvt_pk_bf16_f32 v119, v126, v127
    v_mfma_f32_16x16x32_bf16 v[220:223], a[188:191], v[100:103], v[220:223]
    s_barrier
    v_smfmac_f32_16x16x64_bf16 a[204:207], v[20:23], v[112:119], v29
    ds_read_b128 a[76:79], v47 offset:49152
    v_mfma_f32_16x16x32_bf16 v[224:227], a[128:131], v[112:115], 0
    ds_read_b128 a[96:99], v44 offset:57344
    v_mov_b32 v9, 0
    v_mfma_f32_16x16x32_bf16 v[224:227], a[160:163], v[116:119], v[224:227]
    ds_read_b128 a[68:71], v45 offset:49152
    ds_read_b128 a[72:75], v46 offset:49152
    v_mfma_f32_16x16x32_bf16 v[228:231], a[132:135], v[112:115], 0
    ds_read_b128 a[64:67], v44 offset:49152
    v_mfma_f32_16x16x32_bf16 v[228:231], a[164:167], v[116:119], v[228:231]
    ds_read_b128 a[112:115], v44 offset:61440
    v_mfma_f32_16x16x32_bf16 v[232:235], a[136:139], v[112:115], 0
    s_add_u32 s54, s52, L_s4-L_pc+0
    ds_read_b128 a[124:127], v47 offset:61440
    v_mfma_f32_16x16x32_bf16 v[232:235], a[168:171], v[116:119], v[232:235]
    ds_read_b128 a[100:103], v45 offset:57344
    v_mov_b32 v8, 0x20000
    v_mfma_f32_16x16x32_bf16 v[236:239], a[140:143], v[112:115], 0
    ds_read_b128 a[88:91], v46 offset:53248
    v_mfma_f32_16x16x32_bf16 v[236:239], a[172:175], v[116:119], v[236:239]
    s_addc_u32 s55, s53, 0
    ds_read_b128 a[116:119], v45 offset:61440
    v_mfma_f32_16x16x32_bf16 v[240:243], a[144:147], v[112:115], 0
    ds_read_b128 a[84:87], v45 offset:53248
    ds_read_b128 a[108:111], v47 offset:57344
    v_mfma_f32_16x16x32_bf16 v[240:243], a[176:179], v[116:119], v[240:243]
    s_waitcnt vmcnt(8)
    ds_read_b128 a[104:107], v46 offset:57344
    v_mfma_f32_16x16x32_bf16 v[244:247], a[148:151], v[112:115], 0
    ds_read_b128 a[80:83], v44 offset:53248
    v_mfma_f32_16x16x32_bf16 v[244:247], a[180:183], v[116:119], v[244:247]
    ds_read_b128 a[92:95], v47 offset:53248
    v_mfma_f32_16x16x32_bf16 v[248:251], a[152:155], v[112:115], 0
    s_barrier
    v_mfma_f32_16x16x32_bf16 v[248:251], a[184:187], v[116:119], v[248:251]
    global_load_dwordx4 v[40:43], v7, s[54:55]
    v_mfma_f32_16x16x32_bf16 v[252:255], a[156:159], v[112:115], 0
    ds_read_b64_tr_b16 a[160:161], v36 offset:57344
    v_mfma_f32_16x16x32_bf16 v[252:255], a[188:191], v[116:119], v[252:255]
L_s3:
    s_waitcnt lgkmcnt(7)
    ds_read_b128 a[120:123], v46 offset:61440
    v_mfma_f32_16x16x32_bf16 v[64:67], a[64:67], a[0:3], v[48:51]
    ds_read_b64_tr_b16 a[134:135], v36 offset:53256
    v_mfma_f32_16x16x32_bf16 v[64:67], a[68:71], a[4:7], v[64:67]
    ds_read_b64_tr_b16 a[188:189], v39 offset:57352
    v_mfma_f32_16x16x32_bf16 v[64:67], a[72:75], a[8:11], v[64:67]
    ds_read_b64_tr_b16 a[184:185], v39 offset:57344
    v_mfma_f32_16x16x32_bf16 v[64:67], a[76:79], a[12:15], v[64:67]
    s_waitcnt lgkmcnt(6)
    s_add_u32 m0, s44, 0x14000
    ds_read_b64_tr_b16 a[182:183], v38 offset:61448
    v_mfma_f32_16x16x32_bf16 v[68:71], a[80:83], a[0:3], v[48:51]
    ds_read_b64_tr_b16 a[168:169], v37 offset:57344
    v_mfma_f32_16x16x32_bf16 v[68:71], a[84:87], a[4:7], v[68:71]
    buffer_load_dwordx4 v30, s[20:23], s41 offen offset:0 lds
    v_mfma_f32_16x16x32_bf16 v[68:71], a[88:91], a[8:11], v[68:71]
    s_waitcnt lgkmcnt(7)
    ds_read_b64_tr_b16 a[138:139], v37 offset:53248
    v_mfma_f32_16x16x32_bf16 v[68:71], a[92:95], a[12:15], v[68:71]
    v_exp_f32 v67, v67
    v_mfma_f32_16x16x32_bf16 v[72:75], a[96:99], a[0:3], v[48:51]
    ds_read_b64_tr_b16 a[128:129], v36 offset:49152
    v_mfma_f32_16x16x32_bf16 v[72:75], a[100:103], a[4:7], v[72:75]
    ds_read_b64_tr_b16 a[190:191], v39 offset:61448
    v_exp_f32 v64, v64
    v_mfma_f32_16x16x32_bf16 v[72:75], a[104:107], a[8:11], v[72:75]
    ds_read_b64_tr_b16 a[172:173], v37 offset:57352
    v_exp_f32 v66, v66
    v_mfma_f32_16x16x32_bf16 v[72:75], a[108:111], a[12:15], v[72:75]
    s_waitcnt lgkmcnt(6)
    v_exp_f32 v71, v71
    v_mfma_f32_16x16x32_bf16 v[76:79], a[112:115], a[0:3], v[48:51]
    v_exp_f32 v65, v65
    v_mfma_f32_16x16x32_bf16 v[76:79], a[116:119], a[4:7], v[76:79]
    ds_read_b64_tr_b16 a[170:171], v37 offset:61440
    v_cvt_pk_bf16_f32 v64, v64, v65
    v_mfma_f32_16x16x32_bf16 v[76:79], a[120:123], a[8:11], v[76:79]
    buffer_load_dwordx4 v30, s[20:23], s41 offen offset:1024 lds
    v_mfma_f32_16x16x32_bf16 v[76:79], a[124:127], a[12:15], v[76:79]
    ds_read_b64_tr_b16 a[130:131], v36 offset:53248
    v_mfma_f32_16x16x32_bf16 v[80:83], a[64:67], a[16:19], v[52:55]
    v_exp_f32 v69, v69
    v_mfma_f32_16x16x32_bf16 v[80:83], a[68:71], a[20:23], v[80:83]
    v_exp_f32 v73, v73
    v_mfma_f32_16x16x32_bf16 v[80:83], a[72:75], a[24:27], v[80:83]
    ds_read_b64_tr_b16 a[150:151], v38 offset:53256
    v_cvt_pk_bf16_f32 v65, v66, v67
    v_mfma_f32_16x16x32_bf16 v[80:83], a[76:79], a[28:31], v[80:83]
    v_exp_f32 v77, v77
    v_mfma_f32_16x16x32_bf16 v[84:87], a[80:83], a[16:19], v[52:55]
    v_exp_f32 v72, v72
    v_mfma_f32_16x16x32_bf16 v[84:87], a[84:87], a[20:23], v[84:87]
    v_exp_f32 v75, v75
    v_mfma_f32_16x16x32_bf16 v[84:87], a[88:91], a[24:27], v[84:87]
    buffer_load_dwordx4 v30, s[20:23], s41 offen offset:2048 lds
    v_mfma_f32_16x16x32_bf16 v[84:87], a[92:95], a[28:31], v[84:87]
    ds_read_b64_tr_b16 a[162:163], v36 offset:61440
    v_exp_f32 v70, v70
    v_mfma_f32_16x16x32_bf16 v[88:91], a[96:99], a[16:19], v[52:55]
    v_exp_f32 v79, v79
    v_mfma_f32_16x16x32_bf16 v[88:91], a[100:103], a[20:23], v[88:91]
    ds_read_b64_tr_b16 a[140:141], v37 offset:49160
    v_exp_f32 v68, v68
    v_mfma_f32_16x16x32_bf16 v[88:91], a[104:107], a[24:27], v[88:91]
    ds_read_b64_tr_b16 a[148:149], v38 offset:49160
    v_mfma_f32_16x16x32_bf16 v[88:91], a[108:111], a[28:31], v[88:91]
    ds_read_b64_tr_b16 a[146:147], v38 offset:53248
    v_exp_f32 v81, v81
    v_mfma_f32_16x16x32_bf16 v[92:95], a[112:115], a[16:19], v[52:55]
    v_exp_f32 v78, v78
    v_mfma_f32_16x16x32_bf16 v[92:95], a[116:119], a[20:23], v[92:95]
    v_exp_f32 v74, v74
    v_mfma_f32_16x16x32_bf16 v[92:95], a[120:123], a[24:27], v[92:95]
    v_exp_f32 v76, v76
    v_mfma_f32_16x16x32_bf16 v[92:95], a[124:127], a[28:31], v[92:95]
    ds_read_b64_tr_b16 a[144:145], v38 offset:49152
    v_cvt_pk_bf16_f32 v67, v70, v71
    v_mfma_f32_16x16x32_bf16 v[96:99], a[64:67], a[32:35], v[56:59]
    buffer_load_dwordx4 v30, s[20:23], s41 offen offset:3072 lds
    v_mfma_f32_16x16x32_bf16 v[96:99], a[68:71], a[36:39], v[96:99]
    ds_read_b64_tr_b16 a[186:187], v39 offset:61440
    v_cvt_pk_bf16_f32 v71, v78, v79
    v_mfma_f32_16x16x32_bf16 v[96:99], a[72:75], a[40:43], v[96:99]
    ds_read_b64_tr_b16 a[174:175], v37 offset:61448
    v_cvt_pk_bf16_f32 v66, v68, v69
    v_mfma_f32_16x16x32_bf16 v[96:99], a[76:79], a[44:47], v[96:99]
    ds_read_b64_tr_b16 a[156:157], v39 offset:49160
    v_mfma_f32_16x16x32_bf16 v[100:103], a[80:83], a[32:35], v[56:59]
    v_exp_f32 v94, v94
    v_mfma_f32_16x16x32_bf16 v[100:103], a[84:87], a[36:39], v[100:103]
    ds_read_b64_tr_b16 a[178:179], v38 offset:61440
    v_mfma_f32_16x16x32_bf16 v[100:103], a[88:91], a[40:43], v[100:103]
    v_exp_f32 v87, v87
    v_mfma_f32_16x16x32_bf16 v[100:103], a[92:95], a[44:47], v[100:103]
    s_add_u32 m0, s44, 0x8000
    v_exp_f32 v95, v95
    v_mfma_f32_16x16x32_bf16 v[104:107], a[96:99], a[32:35], v[56:59]
    buffer_load_dwordx4 v32, s[16:19], s42 offen offset:0 lds
    v_mfma_f32_16x16x32_bf16 v[104:107], a[100:103], a[36:39], v[104:107]
    ds_read_b64_tr_b16 a[164:165], v36 offset:57352
    v_cvt_pk_bf16_f32 v69, v74, v75
    v_mfma_f32_16x16x32_bf16 v[104:107], a[104:107], a[40:43], v[104:107]
    ds_read_b64_tr_b16 a[136:137], v37 offset:49152
    v_mfma_f32_16x16x32_bf16 v[104:107], a[108:111], a[44:47], v[104:107]
    v_exp_f32 v82, v82
    v_mfma_f32_16x16x32_bf16 v[108:111], a[112:115], a[32:35], v[56:59]
    v_exp_f32 v92, v92
    v_mfma_f32_16x16x32_bf16 v[108:111], a[116:119], a[36:39], v[108:111]
    ds_read_b64_tr_b16 a[166:167], v36 offset:61448
    v_exp_f32 v83, v83
    v_mfma_f32_16x16x32_bf16 v[108:111], a[120:123], a[40:43], v[108:111]
    v_exp_f32 v90, v90
    v_mfma_f32_16x16x32_bf16 v[108:111], a[124:127], a[44:47], v[108:111]
    v_exp_f32 v86, v86
    v_mfma_f32_16x16x32_bf16 v[112:115], a[64:67], a[48:51], v[60:63]
    ds_read_b64_tr_b16 a[176:177], v38 offset:57344
    v_cvt_pk_bf16_f32 v70, v76, v77
    v_mfma_f32_16x16x32_bf16 v[112:115], a[68:71], a[52:55], v[112:115]
    v_exp_f32 v104, v104
    v_mfma_f32_16x16x32_bf16 v[112:115], a[72:75], a[56:59], v[112:115]
    buffer_load_dwordx4 v33, s[16:19], s42 offen offset:1024 lds
    v_mfma_f32_16x16x32_bf16 v[112:115], a[76:79], a[60:63], v[112:115]
    v_exp_f32 v84, v84
    v_mfma_f32_16x16x32_bf16 v[116:119], a[80:83], a[48:51], v[60:63]
    ds_read_b64_tr_b16 a[132:133], v36 offset:49160
    v_exp_f32 v80, v80
    v_mfma_f32_16x16x32_bf16 v[116:119], a[84:87], a[52:55], v[116:119]
    ds_read_b64_tr_b16 a[152:153], v39 offset:49152
    v_cvt_pk_bf16_f32 v80, v80, v81
    v_mfma_f32_16x16x32_bf16 v[116:119], a[88:91], a[56:59], v[116:119]
    ds_read_b64_tr_b16 a[142:143], v37 offset:53256
    v_cvt_pk_bf16_f32 v81, v82, v83
    v_mfma_f32_16x16x32_bf16 v[116:119], a[92:95], a[60:63], v[116:119]
    v_exp_f32 v102, v102
    v_mfma_f32_16x16x32_bf16 v[120:123], a[96:99], a[48:51], v[60:63]
    v_exp_f32 v99, v99
    v_mfma_f32_16x16x32_bf16 v[120:123], a[100:103], a[52:55], v[120:123]
    ds_read_b64_tr_b16 a[158:159], v39 offset:53256
    v_cvt_pk_bf16_f32 v68, v72, v73
    v_mfma_f32_16x16x32_bf16 v[120:123], a[104:107], a[56:59], v[120:123]
    ds_read_b64_tr_b16 a[180:181], v38 offset:57352
    v_cvt_pk_bf16_f32 v83, v86, v87
    v_mfma_f32_16x16x32_bf16 v[120:123], a[108:111], a[60:63], v[120:123]
    buffer_load_dwordx4 v34, s[16:19], s42 offen offset:2048 lds
    v_mfma_f32_16x16x32_bf16 v[124:127], a[112:115], a[48:51], v[60:63]
    v_exp_f32 v107, v107
    v_mfma_f32_16x16x32_bf16 v[124:127], a[116:119], a[52:55], v[124:127]
    s_waitcnt lgkmcnt(4)
    v_exp_f32 v89, v89
    v_mfma_f32_16x16x32_bf16 v[124:127], a[120:123], a[56:59], v[124:127]
    v_exp_f32 v96, v96
    v_mfma_f32_16x16x32_bf16 v[124:127], a[124:127], a[60:63], v[124:127]
    ds_read_b64_tr_b16 a[154:155], v39 offset:53248
    v_cvt_pk_bf16_f32 v87, v94, v95
    v_smfmac_f32_16x16x64_bf16 a[192:195], v[20:23], v[64:71], v29
    ds_read_b128 a[76:79], v47 offset:0
    v_mfma_f32_16x16x32_bf16 v[128:131], a[128:131], v[64:67], v[128:131]
    v_exp_f32 v91, v91
    v_mfma_f32_16x16x32_bf16 v[128:131], a[160:163], v[68:71], v[128:131]
    v_exp_f32 v88, v88
    v_mfma_f32_16x16x32_bf16 v[132:135], a[132:135], v[64:67], v[132:135]
    s_waitcnt lgkmcnt(2)
    v_exp_f32 v100, v100
    v_mfma_f32_16x16x32_bf16 v[132:135], a[164:167], v[68:71], v[132:135]
    v_exp_f32 v117, v117
    v_mfma_f32_16x16x32_bf16 v[136:139], a[136:139], v[64:67], v[136:139]
    buffer_load_dwordx4 v35, s[16:19], s42 offen offset:3072 lds
    v_mfma_f32_16x16x32_bf16 v[136:139], a[168:171], v[68:71], v[136:139]
    v_exp_f32 v93, v93
    v_mfma_f32_16x16x32_bf16 v[140:143], a[140:143], v[64:67], v[140:143]
    v_exp_f32 v85, v85
    v_mfma_f32_16x16x32_bf16 v[140:143], a[172:175], v[68:71], v[140:143]
    v_exp_f32 v106, v106
    v_mfma_f32_16x16x32_bf16 v[144:147], a[144:147], v[64:67], v[144:147]
    s_waitcnt lgkmcnt(0)
    v_cvt_pk_bf16_f32 v82, v84, v85
    v_cvt_pk_bf16_f32 v85, v90, v91
    v_mfma_f32_16x16x32_bf16 v[144:147], a[176:179], v[68:71], v[144:147]
    v_exp_f32 v97, v97
    v_mfma_f32_16x16x32_bf16 v[148:151], a[148:151], v[64:67], v[148:151]
    v_exp_f32 v113, v113
    v_mfma_f32_16x16x32_bf16 v[148:151], a[180:183], v[68:71], v[148:151]
    ds_read_b128 a[104:107], v46 offset:8192
    v_cvt_pk_bf16_f32 v96, v96, v97
    v_mfma_f32_16x16x32_bf16 v[152:155], a[152:155], v[64:67], v[152:155]
    v_exp_f32 v98, v98
    v_mfma_f32_16x16x32_bf16 v[152:155], a[184:187], v[68:71], v[152:155]
    v_cvt_pk_bf16_f32 v84, v88, v89
    v_cvt_pk_bf16_f32 v86, v92, v93
    v_mfma_f32_16x16x32_bf16 v[156:159], a[156:159], v[64:67], v[156:159]
    v_exp_f32 v111, v111
    v_mfma_f32_16x16x32_bf16 v[156:159], a[188:191], v[68:71], v[156:159]
    v_exp_f32 v110, v110
    v_smfmac_f32_16x16x64_bf16 a[196:199], v[20:23], v[80:87], v29
    ds_read_b128 a[64:67], v44 offset:0
    v_cvt_pk_bf16_f32 v97, v98, v99
    v_mfma_f32_16x16x32_bf16 v[160:163], a[128:131], v[80:83], v[160:163]
    v_exp_f32 v109, v109
    v_mfma_f32_16x16x32_bf16 v[160:163], a[160:163], v[84:87], v[160:163]
L_pg2:
    s_cbranch_execz L_pgret2
    v_exp_f32 v127, v127
    v_mfma_f32_16x16x32_bf16 v[164:167], a[132:135], v[80:83], v[164:167]
    v_exp_f32 v105, v105
    v_mfma_f32_16x16x32_bf16 v[164:167], a[164:167], v[84:87], v[164:167]
    v_exp_f32 v103, v103
    v_mfma_f32_16x16x32_bf16 v[168:171], a[136:139], v[80:83], v[168:171]
    v_exp_f32 v124, v124
    v_mfma_f32_16x16x32_bf16 v[168:171], a[168:171], v[84:87], v[168:171]
    v_exp_f32 v101, v101
    v_mfma_f32_16x16x32_bf16 v[172:175], a[140:143], v[80:83], v[172:175]
    v_exp_f32 v108, v108
    v_mfma_f32_16x16x32_bf16 v[172:175], a[172:175], v[84:87], v[172:175]
    ds_read_b128 a[112:115], v44 offset:12288
    v_cvt_pk_bf16_f32 v99, v102, v103
    v_mfma_f32_16x16x32_bf16 v[176:179], a[144:147], v[80:83], v[176:179]
    v_exp_f32 v112, v112
    v_mfma_f32_16x16x32_bf16 v[176:179], a[176:179], v[84:87], v[176:179]
    v_cvt_pk_bf16_f32 v98, v100, v101
    v_cvt_pk_bf16_f32 v101, v106, v107
    v_mfma_f32_16x16x32_bf16 v[180:183], a[148:151], v[80:83], v[180:183]
    v_cvt_pk_bf16_f32 v100, v104, v105
    v_cvt_pk_bf16_f32 v102, v108, v109
    v_mfma_f32_16x16x32_bf16 v[180:183], a[180:183], v[84:87], v[180:183]
    v_exp_f32 v125, v125
    v_mfma_f32_16x16x32_bf16 v[184:187], a[152:155], v[80:83], v[184:187]
    v_exp_f32 v121, v121
    v_mfma_f32_16x16x32_bf16 v[184:187], a[184:187], v[84:87], v[184:187]
    v_exp_f32 v126, v126
    v_mfma_f32_16x16x32_bf16 v[188:191], a[156:159], v[80:83], v[188:191]
    ds_read_b128 a[84:87], v45 offset:4096
    v_cvt_pk_bf16_f32 v103, v110, v111
    v_mfma_f32_16x16x32_bf16 v[188:191], a[188:191], v[84:87], v[188:191]
    v_exp_f32 v115, v115
    v_smfmac_f32_16x16x64_bf16 a[200:203], v[20:23], v[96:103], v29
    ds_read_b128 a[124:127], v47 offset:12288
    v_cvt_pk_bf16_f32 v112, v112, v113
    v_mfma_f32_16x16x32_bf16 v[192:195], a[128:131], v[96:99], v[192:195]
    v_exp_f32 v114, v114
    v_mfma_f32_16x16x32_bf16 v[192:195], a[160:163], v[100:103], v[192:195]
    ds_read_b128 a[96:99], v44 offset:8192
    v_mfma_f32_16x16x32_bf16 v[196:199], a[132:135], v[96:99], v[196:199]
    v_exp_f32 v123, v123
    v_mfma_f32_16x16x32_bf16 v[196:199], a[164:167], v[100:103], v[196:199]
    ds_read_b128 a[116:119], v45 offset:12288
    v_cvt_pk_bf16_f32 v113, v114, v115
    v_mfma_f32_16x16x32_bf16 v[200:203], a[136:139], v[96:99], v[200:203]
    v_exp_f32 v122, v122
    v_mfma_f32_16x16x32_bf16 v[200:203], a[168:171], v[100:103], v[200:203]
    v_exp_f32 v118, v118
    v_mfma_f32_16x16x32_bf16 v[204:207], a[140:143], v[96:99], v[204:207]
    v_exp_f32 v119, v119
    v_mfma_f32_16x16x32_bf16 v[204:207], a[172:175], v[100:103], v[204:207]
    v_exp_f32 v116, v116
    v_mfma_f32_16x16x32_bf16 v[208:211], a[144:147], v[96:99], v[208:211]
    v_cvt_pk_bf16_f32 v114, v116, v117
    v_cvt_pk_bf16_f32 v117, v122, v123
    v_mfma_f32_16x16x32_bf16 v[208:211], a[176:179], v[100:103], v[208:211]
    ds_read_b128 a[88:91], v46 offset:4096
    v_cvt_pk_bf16_f32 v115, v118, v119
    v_mfma_f32_16x16x32_bf16 v[212:215], a[148:151], v[96:99], v[212:215]
    ds_write_b32 v8, v9
    v_mfma_f32_16x16x32_bf16 v[212:215], a[180:183], v[100:103], v[212:215]
    v_exp_f32 v120, v120
    v_mfma_f32_16x16x32_bf16 v[216:219], a[152:155], v[96:99], v[216:219]
    ds_read_b128 a[108:111], v47 offset:8192
    v_cvt_pk_bf16_f32 v119, v126, v127
    v_mfma_f32_16x16x32_bf16 v[216:219], a[184:187], v[100:103], v[216:219]
    ds_read_b128 a[92:95], v47 offset:4096
    v_cvt_pk_bf16_f32 v116, v120, v121
    v_mfma_f32_16x16x32_bf16 v[220:223], a[156:159], v[96:99], v[220:223]
    ds_read_b128 a[120:123], v46 offset:12288
    v_cvt_pk_bf16_f32 v118, v124, v125
    v_mfma_f32_16x16x32_bf16 v[220:223], a[188:191], v[100:103], v[220:223]
    ds_read_b128 a[72:75], v46 offset:0
    v_smfmac_f32_16x16x64_bf16 a[204:207], v[20:23], v[112:119], v29
    s_waitcnt vmcnt(9)
    ds_read_b128 a[68:71], v45 offset:0
    v_mfma_f32_16x16x32_bf16 v[224:227], a[128:131], v[112:115], v[224:227]
    ds_read_b128 a[100:103], v45 offset:8192
    v_mfma_f32_16x16x32_bf16 v[224:227], a[160:163], v[116:119], v[224:227]
    ds_read_b128 a[80:83], v44 offset:4096
    v_mfma_f32_16x16x32_bf16 v[228:231], a[132:135], v[112:115], v[228:231]
    s_barrier
    v_mfma_f32_16x16x32_bf16 v[228:231], a[164:167], v[116:119], v[228:231]
    s_add_u32 s54, s52, L_s5-L_pc+0
    ds_read_b64_tr_b16 a[134:135], v36 offset:4104
    v_mfma_f32_16x16x32_bf16 v[232:235], a[136:139], v[112:115], v[232:235]
    ds_read_b64_tr_b16 a[136:137], v37 offset:0
    v_mfma_f32_16x16x32_bf16 v[232:235], a[168:171], v[116:119], v[232:235]
    ds_read_b64_tr_b16 a[170:171], v37 offset:12288
    v_mfma_f32_16x16x32_bf16 v[236:239], a[140:143], v[112:115], v[236:239]
    ds_read_b64_tr_b16 a[168:169], v37 offset:8192
    v_mfma_f32_16x16x32_bf16 v[236:239], a[172:175], v[116:119], v[236:239]
    ds_read_b64_tr_b16 a[128:129], v36 offset:0
    v_mfma_f32_16x16x32_bf16 v[240:243], a[144:147], v[112:115], v[240:243]
    ds_read_b64_tr_b16 a[162:163], v36 offset:12288
    v_mfma_f32_16x16x32_bf16 v[240:243], a[176:179], v[116:119], v[240:243]
    ds_read_b64_tr_b16 a[172:173], v37 offset:8200
    v_mfma_f32_16x16x32_bf16 v[244:247], a[148:151], v[112:115], v[244:247]
    s_addc_u32 s55, s53, 0
    ds_read_b64_tr_b16 a[166:167], v36 offset:12296
    v_mfma_f32_16x16x32_bf16 v[244:247], a[180:183], v[116:119], v[244:247]
    global_load_dwordx4 v[40:43], v7, s[54:55]
    v_mfma_f32_16x16x32_bf16 v[248:251], a[152:155], v[112:115], v[248:251]
    ds_read_b64_tr_b16 a[142:143], v37 offset:4104
    v_mfma_f32_16x16x32_bf16 v[248:251], a[184:187], v[116:119], v[248:251]
    ds_read_b64_tr_b16 a[132:133], v36 offset:8
    v_mfma_f32_16x16x32_bf16 v[252:255], a[156:159], v[112:115], v[252:255]
    ds_read_b64_tr_b16 a[158:159], v39 offset:4104
    v_mfma_f32_16x16x32_bf16 v[252:255], a[188:191], v[116:119], v[252:255]
L_s4:
    s_waitcnt lgkmcnt(7)
    ds_read_b64_tr_b16 a[164:165], v36 offset:8200
    ds_read_b64_tr_b16 a[140:141], v37 offset:8
    v_mfma_f32_16x16x32_bf16 v[64:67], a[64:67], a[0:3], v[48:51]
    ds_read_b64_tr_b16 a[186:187], v39 offset:12288
    v_mfma_f32_16x16x32_bf16 v[64:67], a[68:71], a[4:7], v[64:67]
    ds_read_b64_tr_b16 a[174:175], v37 offset:12296
    v_mfma_f32_16x16x32_bf16 v[64:67], a[72:75], a[8:11], v[64:67]
    ds_read_b64_tr_b16 a[184:185], v39 offset:8192
    v_mfma_f32_16x16x32_bf16 v[64:67], a[76:79], a[12:15], v[64:67]
    ds_read_b64_tr_b16 a[176:177], v38 offset:8192
    v_mfma_f32_16x16x32_bf16 v[68:71], a[80:83], a[0:3], v[48:51]
    ds_read_b64_tr_b16 a[180:181], v38 offset:8200
    v_mfma_f32_16x16x32_bf16 v[68:71], a[84:87], a[4:7], v[68:71]
    s_add_u32 m0, s44, 0x1c000
    ds_read_b64_tr_b16 a[144:145], v38 offset:0
    v_mfma_f32_16x16x32_bf16 v[68:71], a[88:91], a[8:11], v[68:71]
    buffer_load_dwordx4 v30, s[20:23], s43 offen offset:0 lds
    v_mfma_f32_16x16x32_bf16 v[68:71], a[92:95], a[12:15], v[68:71]
    v_exp_f32 v65, v65
    v_mfma_f32_16x16x32_bf16 v[72:75], a[96:99], a[0:3], v[48:51]
    ds_read_b64_tr_b16 a[152:153], v39 offset:0
    v_mfma_f32_16x16x32_bf16 v[72:75], a[100:103], a[4:7], v[72:75]
    v_exp_f32 v64, v64
    v_mfma_f32_16x16x32_bf16 v[72:75], a[104:107], a[8:11], v[72:75]
    ds_read_b64_tr_b16 a[150:151], v38 offset:4104
    v_cvt_pk_bf16_f32 v64, v64, v65
    v_mfma_f32_16x16x32_bf16 v[72:75], a[108:111], a[12:15], v[72:75]
    v_exp_f32 v69, v69
    v_mfma_f32_16x16x32_bf16 v[76:79], a[112:115], a[0:3], v[48:51]
    buffer_load_dwordx4 v30, s[20:23], s43 offen offset:1024 lds
    v_mfma_f32_16x16x32_bf16 v[76:79], a[116:119], a[4:7], v[76:79]
    v_exp_f32 v66, v66
    v_mfma_f32_16x16x32_bf16 v[76:79], a[120:123], a[8:11], v[76:79]
    v_exp_f32 v68, v68
    v_mfma_f32_16x16x32_bf16 v[76:79], a[124:127], a[12:15], v[76:79]
    v_exp_f32 v67, v67
    v_mfma_f32_16x16x32_bf16 v[80:83], a[64:67], a[16:19], v[52:55]
    v_exp_f32 v75, v75
    v_mfma_f32_16x16x32_bf16 v[80:83], a[68:71], a[20:23], v[80:83]
    v_exp_f32 v74, v74
    v_mfma_f32_16x16x32_bf16 v[80:83], a[72:75], a[24:27], v[80:83]
    ds_read_b64_tr_b16 a[156:157], v39 offset:8
    v_mfma_f32_16x16x32_bf16 v[80:83], a[76:79], a[28:31], v[80:83]
    v_exp_f32 v79, v79
    v_mfma_f32_16x16x32_bf16 v[84:87], a[80:83], a[16:19], v[52:55]
    v_exp_f32 v71, v71
    v_mfma_f32_16x16x32_bf16 v[84:87], a[84:87], a[20:23], v[84:87]
    ds_read_b64_tr_b16 a[188:189], v39 offset:8200
    v_mfma_f32_16x16x32_bf16 v[84:87], a[88:91], a[24:27], v[84:87]
    v_exp_f32 v78, v78
    v_mfma_f32_16x16x32_bf16 v[84:87], a[92:95], a[28:31], v[84:87]
    ds_read_b64_tr_b16 a[154:155], v39 offset:4096
    v_cvt_pk_bf16_f32 v65, v66, v67
    v_mfma_f32_16x16x32_bf16 v[88:91], a[96:99], a[16:19], v[52:55]
    buffer_load_dwordx4 v30, s[20:23], s43 offen offset:2048 lds
    v_mfma_f32_16x16x32_bf16 v[88:91], a[100:103], a[20:23], v[88:91]
    v_exp_f32 v73, v73
    v_mfma_f32_16x16x32_bf16 v[88:91], a[104:107], a[24:27], v[88:91]
    ds_read_b64_tr_b16 a[160:161], v36 offset:8192
    v_cvt_pk_bf16_f32 v66, v68, v69
    v_mfma_f32_16x16x32_bf16 v[88:91], a[108:111], a[28:31], v[88:91]
    v_exp_f32 v77, v77
    v_mfma_f32_16x16x32_bf16 v[92:95], a[112:115], a[16:19], v[52:55]
    v_exp_f32 v82, v82
    v_mfma_f32_16x16x32_bf16 v[92:95], a[116:119], a[20:23], v[92:95]
    v_exp_f32 v70, v70
    v_mfma_f32_16x16x32_bf16 v[92:95], a[120:123], a[24:27], v[92:95]
    buffer_load_dwordx4 v30, s[20:23], s43 offen offset:3072 lds
    v_mfma_f32_16x16x32_bf16 v[92:95], a[124:127], a[28:31], v[92:95]
    v_exp_f32 v72, v72
    v_mfma_f32_16x16x32_bf16 v[96:99], a[64:67], a[32:35], v[56:59]
    v_exp_f32 v76, v76
    v_mfma_f32_16x16x32_bf16 v[96:99], a[68:71], a[36:39], v[96:99]
    v_exp_f32 v80, v80
    v_mfma_f32_16x16x32_bf16 v[96:99], a[72:75], a[40:43], v[96:99]
    v_exp_f32 v84, v84
    v_mfma_f32_16x16x32_bf16 v[96:99], a[76:79], a[44:47], v[96:99]
    v_exp_f32 v85, v85
    v_mfma_f32_16x16x32_bf16 v[100:103], a[80:83], a[32:35], v[56:59]
    ds_read_b64_tr_b16 a[130:131], v36 offset:4096
    v_cvt_pk_bf16_f32 v67, v70, v71
    v_mfma_f32_16x16x32_bf16 v[100:103], a[84:87], a[36:39], v[100:103]
    ds_read_b64_tr_b16 a[138:139], v37 offset:4096
    v_cvt_pk_bf16_f32 v71, v78, v79
    v_mfma_f32_16x16x32_bf16 v[100:103], a[88:91], a[40:43], v[100:103]
    v_exp_f32 v81, v81
    v_mfma_f32_16x16x32_bf16 v[100:103], a[92:95], a[44:47], v[100:103]
    s_add_u32 m0, s44, 0x18000
    v_exp_f32 v93, v93
    v_mfma_f32_16x16x32_bf16 v[104:107], a[96:99], a[32:35], v[56:59]
    v_exp_f32 v96, v96
    v_mfma_f32_16x16x32_bf16 v[104:107], a[100:103], a[36:39], v[104:107]
    ds_read_b64_tr_b16 a[190:191], v39 offset:12296
    v_cvt_pk_bf16_f32 v70, v76, v77
    v_mfma_f32_16x16x32_bf16 v[104:107], a[104:107], a[40:43], v[104:107]
    buffer_load_dwordx4 v30, s[20:23], s42 offen offset:0 lds
    v_mfma_f32_16x16x32_bf16 v[104:107], a[108:111], a[44:47], v[104:107]
    ds_read_b64_tr_b16 a[178:179], v38 offset:12288
    v_mfma_f32_16x16x32_bf16 v[108:111], a[112:115], a[32:35], v[56:59]
    ds_read_b64_tr_b16 a[146:147], v38 offset:4096
    v_cvt_pk_bf16_f32 v68, v72, v73
    v_mfma_f32_16x16x32_bf16 v[108:111], a[116:119], a[36:39], v[108:111]
    v_exp_f32 v103, v103
    v_mfma_f32_16x16x32_bf16 v[108:111], a[120:123], a[40:43], v[108:111]
    v_exp_f32 v86, v86
    v_mfma_f32_16x16x32_bf16 v[108:111], a[124:127], a[44:47], v[108:111]
    ds_read_b64_tr_b16 a[148:149], v38 offset:8
    v_cvt_pk_bf16_f32 v69, v74, v75
    v_mfma_f32_16x16x32_bf16 v[112:115], a[64:67], a[48:51], v[60:63]
    v_exp_f32 v107, v107
    v_mfma_f32_16x16x32_bf16 v[112:115], a[68:71], a[52:55], v[112:115]
    v_exp_f32 v92, v92
    v_mfma_f32_16x16x32_bf16 v[112:115], a[72:75], a[56:59], v[112:115]
    buffer_load_dwordx4 v30, s[20:23], s42 offen offset:1024 lds
    v_mfma_f32_16x16x32_bf16 v[112:115], a[76:79], a[60:63], v[112:115]
    v_exp_f32 v87, v87
    v_mfma_f32_16x16x32_bf16 v[116:119], a[80:83], a[48:51], v[60:63]
    v_exp_f32 v108, v108
    v_mfma_f32_16x16x32_bf16 v[116:119], a[84:87], a[52:55], v[116:119]
    v_exp_f32 v95, v95
    v_mfma_f32_16x16x32_bf16 v[116:119], a[88:91], a[56:59], v[116:119]
    ds_read_b64_tr_b16 a[182:183], v38 offset:12296
    v_cvt_pk_bf16_f32 v80, v80, v81
    v_mfma_f32_16x16x32_bf16 v[116:119], a[92:95], a[60:63], v[116:119]
    v_exp_f32 v99, v99
    v_mfma_f32_16x16x32_bf16 v[120:123], a[96:99], a[48:51], v[60:63]
    v_exp_f32 v94, v94
    v_mfma_f32_16x16x32_bf16 v[120:123], a[100:103], a[52:55], v[120:123]
    v_exp_f32 v91, v91
    v_mfma_f32_16x16x32_bf16 v[120:123], a[104:107], a[56:59], v[120:123]
    buffer_load_dwordx4 v30, s[20:23], s42 offen offset:2048 lds
    v_mfma_f32_16x16x32_bf16 v[120:123], a[108:111], a[60:63], v[120:123]
    v_exp_f32 v97, v97
    v_mfma_f32_16x16x32_bf16 v[124:127], a[112:115], a[48:51], v[60:63]
    v_exp_f32 v118, v118
    v_mfma_f32_16x16x32_bf16 v[124:127], a[116:119], a[52:55], v[124:127]
    s_waitcnt lgkmcnt(1)
    v_exp_f32 v109, v109
    v_mfma_f32_16x16x32_bf16 v[124:127], a[120:123], a[56:59], v[124:127]
    v_exp_f32 v83, v83
    v_mfma_f32_16x16x32_bf16 v[124:127], a[124:127], a[60:63], v[124:127]
    ds_read_b128 a[116:119], v45 offset:28672
    v_cvt_pk_bf16_f32 v81, v82, v83
    v_smfmac_f32_16x16x64_bf16 a[192:195], v[20:23], v[64:71], v29
    ds_read_b128 a[92:95], v47 offset:20480
    v_cvt_pk_bf16_f32 v83, v86, v87
    v_mfma_f32_16x16x32_bf16 v[128:131], a[128:131], v[64:67], v[128:131]
    v_exp_f32 v101, v101
    v_mfma_f32_16x16x32_bf16 v[128:131], a[160:163], v[68:71], v[128:131]
    buffer_load_dwordx4 v30, s[20:23], s42 offen offset:3072 lds
    v_mfma_f32_16x16x32_bf16 v[132:135], a[132:135], v[64:67], v[132:135]
    v_exp_f32 v89, v89
    v_mfma_f32_16x16x32_bf16 v[132:135], a[164:167], v[68:71], v[132:135]
    ds_read_b128 a[68:71], v45 offset:16384
    v_cvt_pk_bf16_f32 v82, v84, v85
    v_mfma_f32_16x16x32_bf16 v[136:139], a[136:139], v[64:67], v[136:139]
    v_exp_f32 v102, v102
    v_mfma_f32_16x16x32_bf16 v[136:139], a[168:171], v[68:71], v[136:139]
    v_exp_f32 v90, v90
    v_mfma_f32_16x16x32_bf16 v[140:143], a[140:143], v[64:67], v[140:143]
    v_exp_f32 v88, v88
    v_mfma_f32_16x16x32_bf16 v[140:143], a[172:175], v[68:71], v[140:143]
    ds_read_b128 a[72:75], v46 offset:16384
    v_cvt_pk_bf16_f32 v84, v88, v89
    v_mfma_f32_16x16x32_bf16 v[144:147], a[144:147], v[64:67], v[144:147]
    s_waitcnt lgkmcnt(2)
    v_exp_f32 v122, v122
    v_mfma_f32_16x16x32_bf16 v[144:147], a[176:179], v[68:71], v[144:147]
    ds_read_b128 a[64:67], v44 offset:16384
    v_cvt_pk_bf16_f32 v86, v92, v93
    v_mfma_f32_16x16x32_bf16 v[148:151], a[148:151], v[64:67], v[148:151]
    ds_read_b128 a[120:123], v46 offset:28672
    v_cvt_pk_bf16_f32 v85, v90, v91
    v_mfma_f32_16x16x32_bf16 v[148:151], a[180:183], v[68:71], v[148:151]
    s_add_u32 m0, s44, 0xc000
    v_exp_f32 v117, v117
    v_mfma_f32_16x16x32_bf16 v[152:155], a[152:155], v[64:67], v[152:155]
    v_exp_f32 v98, v98
    v_mfma_f32_16x16x32_bf16 v[152:155], a[184:187], v[68:71], v[152:155]
    buffer_load_dwordx4 v32, s[16:19], s43 offen offset:0 lds
    v_mfma_f32_16x16x32_bf16 v[156:159], a[156:159], v[64:67], v[156:159]
    ds_read_b128 a[108:111], v47 offset:24576
    v_cvt_pk_bf16_f32 v87, v94, v95
    v_mfma_f32_16x16x32_bf16 v[156:159], a[188:191], v[68:71], v[156:159]
    v_exp_f32 v110, v110
    v_smfmac_f32_16x16x64_bf16 a[196:199], v[20:23], v[80:87], v29
    ds_read_b128 a[104:107], v46 offset:24576
    v_cvt_pk_bf16_f32 v96, v96, v97
    v_mfma_f32_16x16x32_bf16 v[160:163], a[128:131], v[80:83], v[160:163]
    v_exp_f32 v105, v105
    v_mfma_f32_16x16x32_bf16 v[160:163], a[160:163], v[84:87], v[160:163]
    v_exp_f32 v112, v112
    v_mfma_f32_16x16x32_bf16 v[164:167], a[132:135], v[80:83], v[164:167]
    buffer_load_dwordx4 v33, s[16:19], s43 offen offset:1024 lds
    v_mfma_f32_16x16x32_bf16 v[164:167], a[164:167], v[84:87], v[164:167]
    v_exp_f32 v111, v111
    v_mfma_f32_16x16x32_bf16 v[168:171], a[136:139], v[80:83], v[168:171]
    v_exp_f32 v104, v104
    v_mfma_f32_16x16x32_bf16 v[168:171], a[168:171], v[84:87], v[168:171]
    v_exp_f32 v100, v100
    v_mfma_f32_16x16x32_bf16 v[172:175], a[140:143], v[80:83], v[172:175]
    v_exp_f32 v115, v115
    v_mfma_f32_16x16x32_bf16 v[172:175], a[172:175], v[84:87], v[172:175]
    v_exp_f32 v106, v106
    v_mfma_f32_16x16x32_bf16 v[176:179], a[144:147], v[80:83], v[176:179]
    ds_read_b128 a[96:99], v44 offset:24576
    v_cvt_pk_bf16_f32 v97, v98, v99
    v_mfma_f32_16x16x32_bf16 v[176:179], a[176:179], v[84:87], v[176:179]
    ds_read_b128 a[88:91], v46 offset:20480
    v_cvt_pk_bf16_f32 v99, v102, v103
    v_mfma_f32_16x16x32_bf16 v[180:183], a[148:151], v[80:83], v[180:183]
    ds_read_b128 a[80:83], v44 offset:20480
    v_cvt_pk_bf16_f32 v98, v100, v101
    v_mfma_f32_16x16x32_bf16 v[180:183], a[180:183], v[84:87], v[180:183]
    ds_read_b128 a[112:115], v44 offset:28672
    v_cvt_pk_bf16_f32 v101, v106, v107
    v_mfma_f32_16x16x32_bf16 v[184:187], a[152:155], v[80:83], v[184:187]
    ds_read_b128 a[124:127], v47 offset:28672
    v_cvt_pk_bf16_f32 v103, v110, v111
    v_mfma_f32_16x16x32_bf16 v[184:187], a[184:187], v[84:87], v[184:187]
    buffer_load_dwordx4 v34, s[16:19], s43 offen offset:2048 lds
    v_mfma_f32_16x16x32_bf16 v[188:191], a[156:159], v[80:83], v[188:191]
    v_cvt_pk_bf16_f32 v100, v104, v105
    v_cvt_pk_bf16_f32 v102, v108, v109
    v_mfma_f32_16x16x32_bf16 v[188:191], a[188:191], v[84:87], v[188:191]
    v_exp_f32 v119, v119
    v_smfmac_f32_16x16x64_bf16 a[200:203], v[20:23], v[96:103], v29
    ds_read_b128 a[100:103], v45 offset:24576
    v_mfma_f32_16x16x32_bf16 v[192:195], a[128:131], v[96:99], v[192:195]
    v_exp_f32 v116, v116
    v_mfma_f32_16x16x32_bf16 v[192:195], a[160:163], v[100:103], v[192:195]
    v_exp_f32 v114, v114
    v_mfma_f32_16x16x32_bf16 v[196:199], a[132:135], v[96:99], v[196:199]
    v_exp_f32 v126, v126
    v_mfma_f32_16x16x32_bf16 v[196:199], a[164:167], v[100:103], v[196:199]
    v_exp_f32 v127, v127
    v_mfma_f32_16x16x32_bf16 v[200:203], a[136:139], v[96:99], v[200:203]
    v_exp_f32 v120, v120
    v_mfma_f32_16x16x32_bf16 v[200:203], a[168:171], v[100:103], v[200:203]
    buffer_load_dwordx4 v35, s[16:19], s43 offen offset:3072 lds
    v_mfma_f32_16x16x32_bf16 v[204:207], a[140:143], v[96:99], v[204:207]
    v_exp_f32 v113, v113
    v_mfma_f32_16x16x32_bf16 v[204:207], a[172:175], v[100:103], v[204:207]
    v_exp_f32 v121, v121
    v_mfma_f32_16x16x32_bf16 v[208:211], a[144:147], v[96:99], v[208:211]
    v_cvt_pk_bf16_f32 v112, v112, v113
    v_cvt_pk_bf16_f32 v113, v114, v115
    v_mfma_f32_16x16x32_bf16 v[208:211], a[176:179], v[100:103], v[208:211]
    v_exp_f32 v123, v123
    v_mfma_f32_16x16x32_bf16 v[212:215], a[148:151], v[96:99], v[212:215]
    v_exp_f32 v124, v124
    v_mfma_f32_16x16x32_bf16 v[212:215], a[180:183], v[100:103], v[212:215]
    v_cvt_pk_bf16_f32 v114, v116, v117
    v_cvt_pk_bf16_f32 v115, v118, v119
    v_mfma_f32_16x16x32_bf16 v[216:219], a[152:155], v[96:99], v[216:219]
    v_cvt_pk_bf16_f32 v116, v120, v121
    v_cvt_pk_bf16_f32 v117, v122, v123
    v_mfma_f32_16x16x32_bf16 v[216:219], a[184:187], v[100:103], v[216:219]
    v_exp_f32 v125, v125
    v_mfma_f32_16x16x32_bf16 v[220:223], a[156:159], v[96:99], v[220:223]
    v_cvt_pk_bf16_f32 v118, v124, v125
    v_cvt_pk_bf16_f32 v119, v126, v127
    v_mfma_f32_16x16x32_bf16 v[220:223], a[188:191], v[100:103], v[220:223]
    ds_read_b128 a[76:79], v47 offset:16384
    v_smfmac_f32_16x16x64_bf16 a[204:207], v[20:23], v[112:119], v29
    s_waitcnt vmcnt(13)
    ds_read_b128 a[84:87], v45 offset:20480
    v_mfma_f32_16x16x32_bf16 v[224:227], a[128:131], v[112:115], v[224:227]
    s_barrier
    v_mfma_f32_16x16x32_bf16 v[224:227], a[160:163], v[116:119], v[224:227]
    s_add_u32 s54, s52, L_s6-L_pc+0
    ds_read_b64_tr_b16 a[162:163], v36 offset:28672
    v_mfma_f32_16x16x32_bf16 v[228:231], a[132:135], v[112:115], v[228:231]
    ds_read_b64_tr_b16 a[130:131], v36 offset:20480
    v_mfma_f32_16x16x32_bf16 v[228:231], a[164:167], v[116:119], v[228:231]
    ds_read_b64_tr_b16 a[160:161], v36 offset:24576
    v_mfma_f32_16x16x32_bf16 v[232:235], a[136:139], v[112:115], v[232:235]
    ds_read_b64_tr_b16 a[136:137], v37 offset:16384
    v_mfma_f32_16x16x32_bf16 v[232:235], a[168:171], v[116:119], v[232:235]
    ds_read_b64_tr_b16 a[166:167], v36 offset:28680
    v_mfma_f32_16x16x32_bf16 v[236:239], a[140:143], v[112:115], v[236:239]
    ds_read_b64_tr_b16 a[138:139], v37 offset:20480
    v_mfma_f32_16x16x32_bf16 v[236:239], a[172:175], v[116:119], v[236:239]
    ds_read_b64_tr_b16 a[132:133], v36 offset:16392
    v_mfma_f32_16x16x32_bf16 v[240:243], a[144:147], v[112:115], v[240:243]
    ds_read_b64_tr_b16 a[128:129], v36 offset:16384
    v_mfma_f32_16x16x32_bf16 v[240:243], a[176:179], v[116:119], v[240:243]
    s_addc_u32 s55, s53, 0
    ds_read_b64_tr_b16 a[140:141], v37 offset:16392
    v_mfma_f32_16x16x32_bf16 v[244:247], a[148:151], v[112:115], v[244:247]
    global_load_dwordx4 v[40:43], v7, s[54:55]
    v_mfma_f32_16x16x32_bf16 v[244:247], a[180:183], v[116:119], v[244:247]
    ds_read_b64_tr_b16 a[174:175], v37 offset:28680
    v_mfma_f32_16x16x32_bf16 v[248:251], a[152:155], v[112:115], v[248:251]
    ds_read_b64_tr_b16 a[180:181], v38 offset:24584
    v_mfma_f32_16x16x32_bf16 v[248:251], a[184:187], v[116:119], v[248:251]
    ds_read_b64_tr_b16 a[170:171], v37 offset:28672
    v_mfma_f32_16x16x32_bf16 v[252:255], a[156:159], v[112:115], v[252:255]
    ds_read_b64_tr_b16 a[144:145], v38 offset:16384
    v_mfma_f32_16x16x32_bf16 v[252:255], a[188:191], v[116:119], v[252:255]
L_final:
L_s5:
    s_waitcnt lgkmcnt(7)
    ds_read_b64_tr_b16 a[182:183], v38 offset:28680
    v_mfma_f32_16x16x32_bf16 v[64:67], a[64:67], a[0:3], v[48:51]
    ds_read_b64_tr_b16 a[168:169], v37 offset:24576
    v_mfma_f32_16x16x32_bf16 v[64:67], a[68:71], a[4:7], v[64:67]
    ds_read_b64_tr_b16 a[186:187], v39 offset:28672
    v_mfma_f32_16x16x32_bf16 v[64:67], a[72:75], a[8:11], v[64:67]
    ds_read_b64_tr_b16 a[150:151], v38 offset:20488
    v_mfma_f32_16x16x32_bf16 v[64:67], a[76:79], a[12:15], v[64:67]
    ds_read_b64_tr_b16 a[176:177], v38 offset:24576
    v_mfma_f32_16x16x32_bf16 v[68:71], a[80:83], a[0:3], v[48:51]
    s_add_u32 m0, s44, 0x10000
    ds_read_b64_tr_b16 a[158:159], v39 offset:20488
    v_mfma_f32_16x16x32_bf16 v[68:71], a[84:87], a[4:7], v[68:71]
    buffer_load_dwordx4 v30, s[20:23], s36 offen offset:0 lds
    v_mfma_f32_16x16x32_bf16 v[68:71], a[88:91], a[8:11], v[68:71]
    ds_read_b64_tr_b16 a[172:173], v37 offset:24584
    v_mfma_f32_16x16x32_bf16 v[68:71], a[92:95], a[12:15], v[68:71]
    v_exp_f32 v64, v64
    v_mfma_f32_16x16x32_bf16 v[72:75], a[96:99], a[0:3], v[48:51]
    v_exp_f32 v65, v65
    v_mfma_f32_16x16x32_bf16 v[72:75], a[100:103], a[4:7], v[72:75]
    ds_read_b64_tr_b16 a[148:149], v38 offset:16392
    v_cvt_pk_bf16_f32 v64, v64, v65
    v_mfma_f32_16x16x32_bf16 v[72:75], a[104:107], a[8:11], v[72:75]
    ds_read_b64_tr_b16 a[152:153], v39 offset:16384
    v_mfma_f32_16x16x32_bf16 v[72:75], a[108:111], a[12:15], v[72:75]
    v_exp_f32 v70, v70
    v_mfma_f32_16x16x32_bf16 v[76:79], a[112:115], a[0:3], v[48:51]
    buffer_load_dwordx4 v30, s[20:23], s36 offen offset:1024 lds
    v_mfma_f32_16x16x32_bf16 v[76:79], a[116:119], a[4:7], v[76:79]
    v_exp_f32 v67, v67
    v_mfma_f32_16x16x32_bf16 v[76:79], a[120:123], a[8:11], v[76:79]
    v_exp_f32 v66, v66
    v_mfma_f32_16x16x32_bf16 v[76:79], a[124:127], a[12:15], v[76:79]
    v_exp_f32 v71, v71
    v_mfma_f32_16x16x32_bf16 v[80:83], a[64:67], a[16:19], v[52:55]
    v_exp_f32 v72, v72
    v_mfma_f32_16x16x32_bf16 v[80:83], a[68:71], a[20:23], v[80:83]
    v_exp_f32 v75, v75
    v_mfma_f32_16x16x32_bf16 v[80:83], a[72:75], a[24:27], v[80:83]
    v_exp_f32 v69, v69
    v_mfma_f32_16x16x32_bf16 v[80:83], a[76:79], a[28:31], v[80:83]
    v_exp_f32 v73, v73
    v_mfma_f32_16x16x32_bf16 v[84:87], a[80:83], a[16:19], v[52:55]
    ds_read_b64_tr_b16 a[178:179], v38 offset:28672
    v_exp_f32 v78, v78
    v_mfma_f32_16x16x32_bf16 v[84:87], a[84:87], a[20:23], v[84:87]
    buffer_load_dwordx4 v30, s[20:23], s36 offen offset:2048 lds
    v_mfma_f32_16x16x32_bf16 v[84:87], a[88:91], a[24:27], v[84:87]
    v_exp_f32 v74, v74
    v_mfma_f32_16x16x32_bf16 v[84:87], a[92:95], a[28:31], v[84:87]
    v_exp_f32 v82, v82
    v_mfma_f32_16x16x32_bf16 v[88:91], a[96:99], a[16:19], v[52:55]
    ds_read_b64_tr_b16 a[142:143], v37 offset:20488
    v_cvt_pk_bf16_f32 v65, v66, v67
    v_mfma_f32_16x16x32_bf16 v[88:91], a[100:103], a[20:23], v[88:91]
    v_exp_f32 v81, v81
    v_mfma_f32_16x16x32_bf16 v[88:91], a[104:107], a[24:27], v[88:91]
    v_exp_f32 v83, v83
    v_mfma_f32_16x16x32_bf16 v[88:91], a[108:111], a[28:31], v[88:91]
    v_exp_f32 v79, v79
    v_mfma_f32_16x16x32_bf16 v[92:95], a[112:115], a[16:19], v[52:55]
    v_exp_f32 v68, v68
    v_mfma_f32_16x16x32_bf16 v[92:95], a[116:119], a[20:23], v[92:95]
    ds_read_b64_tr_b16 a[134:135], v36 offset:20488
    v_cvt_pk_bf16_f32 v66, v68, v69
    v_mfma_f32_16x16x32_bf16 v[92:95], a[120:123], a[24:27], v[92:95]
    v_exp_f32 v80, v80
    v_mfma_f32_16x16x32_bf16 v[92:95], a[124:127], a[28:31], v[92:95]
    buffer_load_dwordx4 v30, s[20:23], s36 offen offset:3072 lds
    v_mfma_f32_16x16x32_bf16 v[96:99], a[64:67], a[32:35], v[56:59]
    ds_read_b64_tr_b16 a[164:165], v36 offset:24584
    v_cvt_pk_bf16_f32 v80, v80, v81
    v_mfma_f32_16x16x32_bf16 v[96:99], a[68:71], a[36:39], v[96:99]
    ds_read_b64_tr_b16 a[156:157], v39 offset:16392
    v_cvt_pk_bf16_f32 v67, v70, v71
    v_mfma_f32_16x16x32_bf16 v[96:99], a[72:75], a[40:43], v[96:99]
    v_exp_f32 v77, v77
    v_mfma_f32_16x16x32_bf16 v[96:99], a[76:79], a[44:47], v[96:99]
    v_exp_f32 v76, v76
    v_mfma_f32_16x16x32_bf16 v[100:103], a[80:83], a[32:35], v[56:59]
    ds_read_b64_tr_b16 a[146:147], v38 offset:20480
    v_cvt_pk_bf16_f32 v69, v74, v75
    v_mfma_f32_16x16x32_bf16 v[100:103], a[84:87], a[36:39], v[100:103]
    v_exp_f32 v84, v84
    v_mfma_f32_16x16x32_bf16 v[100:103], a[88:91], a[40:43], v[100:103]
    ds_read_b64_tr_b16 a[190:191], v39 offset:28680
    v_cvt_pk_bf16_f32 v81, v82, v83
    v_mfma_f32_16x16x32_bf16 v[100:103], a[92:95], a[44:47], v[100:103]
    s_add_u32 m0, s44, 0x0
    v_exp_f32 v98, v98
    v_mfma_f32_16x16x32_bf16 v[104:107], a[96:99], a[32:35], v[56:59]
    buffer_load_dwordx4 v32, s[16:19], s36 offen offset:0 lds
    v_mfma_f32_16x16x32_bf16 v[104:107], a[100:103], a[36:39], v[104:107]
    ds_read_b64_tr_b16 a[188:189], v39 offset:24584
    v_cvt_pk_bf16_f32 v71, v78, v79
    v_mfma_f32_16x16x32_bf16 v[104:107], a[104:107], a[40:43], v[104:107]
    v_exp_f32 v91, v91
    v_mfma_f32_16x16x32_bf16 v[104:107], a[108:111], a[44:47], v[104:107]
    v_exp_f32 v88, v88
    v_mfma_f32_16x16x32_bf16 v[108:111], a[112:115], a[32:35], v[56:59]
    ds_read_b64_tr_b16 a[154:155], v39 offset:20480
    v_exp_f32 v95, v95
    v_mfma_f32_16x16x32_bf16 v[108:111], a[116:119], a[36:39], v[108:111]
    v_exp_f32 v86, v86
    v_mfma_f32_16x16x32_bf16 v[108:111], a[120:123], a[40:43], v[108:111]
    v_exp_f32 v99, v99
    v_mfma_f32_16x16x32_bf16 v[108:111], a[124:127], a[44:47], v[108:111]
    v_exp_f32 v101, v101
    v_mfma_f32_16x16x32_bf16 v[112:115], a[64:67], a[48:51], v[60:63]
    buffer_load_dwordx4 v33, s[16:19], s36 offen offset:1024 lds
    v_mfma_f32_16x16x32_bf16 v[112:115], a[68:71], a[52:55], v[112:115]
    s_waitcnt vmcnt(15)
    v_exp_f32 v90, v90
    v_mfma_f32_16x16x32_bf16 v[112:115], a[72:75], a[56:59], v[112:115]
    v_exp_f32 v87, v87
    v_mfma_f32_16x16x32_bf16 v[112:115], a[76:79], a[60:63], v[112:115]
    v_exp_f32 v102, v102
    v_mfma_f32_16x16x32_bf16 v[116:119], a[80:83], a[48:51], v[60:63]
    v_exp_f32 v109, v109
    v_mfma_f32_16x16x32_bf16 v[116:119], a[84:87], a[52:55], v[116:119]
    v_exp_f32 v93, v93
    v_mfma_f32_16x16x32_bf16 v[116:119], a[88:91], a[56:59], v[116:119]
    v_exp_f32 v97, v97
    v_mfma_f32_16x16x32_bf16 v[116:119], a[92:95], a[60:63], v[116:119]
    v_exp_f32 v94, v94
    v_mfma_f32_16x16x32_bf16 v[120:123], a[96:99], a[48:51], v[60:63]
    v_exp_f32 v92, v92
    v_mfma_f32_16x16x32_bf16 v[120:123], a[100:103], a[52:55], v[120:123]
    s_barrier
    v_mfma_f32_16x16x32_bf16 v[120:123], a[104:107], a[56:59], v[120:123]
    ds_read_b64_tr_b16 a[184:185], v39 offset:24576
    v_cvt_pk_bf16_f32 v70, v76, v77
    v_mfma_f32_16x16x32_bf16 v[120:123], a[108:111], a[60:63], v[120:123]
    v_exp_f32 v89, v89
    v_mfma_f32_16x16x32_bf16 v[124:127], a[112:115], a[48:51], v[60:63]
    buffer_load_dwordx4 v34, s[16:19], s36 offen offset:2048 lds
    v_mfma_f32_16x16x32_bf16 v[124:127], a[116:119], a[52:55], v[124:127]
    ds_read_b64_tr_b16 a[226:227], v37 offset:53248
    v_cvt_pk_bf16_f32 v68, v72, v73
    v_mfma_f32_16x16x32_bf16 v[124:127], a[120:123], a[56:59], v[124:127]
    s_waitcnt lgkmcnt(2)
    v_exp_f32 v118, v118
    v_mfma_f32_16x16x32_bf16 v[124:127], a[124:127], a[60:63], v[124:127]
    v_exp_f32 v103, v103
    v_smfmac_f32_16x16x64_bf16 a[192:195], v[20:23], v[64:71], v29
    ds_read_b128 a[68:71], v45 offset:32768
    v_mfma_f32_16x16x32_bf16 v[128:131], a[128:131], v[64:67], v[128:131]
    ds_read_b64_tr_b16 a[216:217], v36 offset:49160
    v_cvt_pk_bf16_f32 v83, v86, v87
    v_mfma_f32_16x16x32_bf16 v[128:131], a[160:163], v[68:71], v[128:131]
    v_exp_f32 v96, v96
    v_mfma_f32_16x16x32_bf16 v[132:135], a[132:135], v[64:67], v[132:135]
    buffer_load_dwordx4 v35, s[16:19], s36 offen offset:3072 lds
    v_mfma_f32_16x16x32_bf16 v[132:135], a[164:167], v[68:71], v[132:135]
    ds_read_b128 a[100:103], v45 offset:40960
    v_cvt_pk_bf16_f32 v86, v92, v93
    v_mfma_f32_16x16x32_bf16 v[136:139], a[136:139], v[64:67], v[136:139]
    ds_read_b128 a[72:75], v46 offset:32768
    v_cvt_pk_bf16_f32 v96, v96, v97
    v_mfma_f32_16x16x32_bf16 v[136:139], a[168:171], v[68:71], v[136:139]
    ds_read_b128 a[108:111], v47 offset:40960
    v_mfma_f32_16x16x32_bf16 v[140:143], a[140:143], v[64:67], v[140:143]
    v_exp_f32 v110, v110
    v_mfma_f32_16x16x32_bf16 v[140:143], a[172:175], v[68:71], v[140:143]
    v_exp_f32 v107, v107
    v_mfma_f32_16x16x32_bf16 v[144:147], a[144:147], v[64:67], v[144:147]
    v_exp_f32 v85, v85
    v_mfma_f32_16x16x32_bf16 v[144:147], a[176:179], v[68:71], v[144:147]
L_pg3:
    s_cbranch_execz L_pgret3
    ds_read_b128 a[112:115], v44 offset:45056
    v_cvt_pk_bf16_f32 v82, v84, v85
    v_mfma_f32_16x16x32_bf16 v[148:151], a[148:151], v[64:67], v[148:151]
    ds_read_b64_tr_b16 a[230:231], v37 offset:61440
    v_cvt_pk_bf16_f32 v85, v90, v91
    v_mfma_f32_16x16x32_bf16 v[148:151], a[180:183], v[68:71], v[148:151]
    ds_read_b64_tr_b16 a[214:215], v36 offset:61440
    v_cvt_pk_bf16_f32 v87, v94, v95
    v_mfma_f32_16x16x32_bf16 v[152:155], a[152:155], v[64:67], v[152:155]
    s_waitcnt lgkmcnt(5)
    v_exp_f32 v100, v100
    v_mfma_f32_16x16x32_bf16 v[152:155], a[184:187], v[68:71], v[152:155]
    v_exp_f32 v113, v113
    v_mfma_f32_16x16x32_bf16 v[156:159], a[156:159], v[64:67], v[156:159]
    ds_read_b64_tr_b16 a[244:245], v38 offset:57344
    v_cvt_pk_bf16_f32 v84, v88, v89
    v_mfma_f32_16x16x32_bf16 v[156:159], a[188:191], v[68:71], v[156:159]
    v_exp_f32 v114, v114
    v_smfmac_f32_16x16x64_bf16 a[196:199], v[20:23], v[80:87], v29
    ds_read_b64_tr_b16 a[238:239], v37 offset:61448
    v_cvt_pk_bf16_f32 v97, v98, v99
    v_mfma_f32_16x16x32_bf16 v[160:163], a[128:131], v[80:83], v[160:163]
    ds_read_b64_tr_b16 a[236:237], v37 offset:57352
    v_cvt_pk_bf16_f32 v98, v100, v101
    v_mfma_f32_16x16x32_bf16 v[160:163], a[160:163], v[84:87], v[160:163]
    v_exp_f32 v111, v111
    v_mfma_f32_16x16x32_bf16 v[164:167], a[132:135], v[80:83], v[164:167]
    ds_read_b128 a[104:107], v46 offset:40960
    v_exp_f32 v108, v108
    v_mfma_f32_16x16x32_bf16 v[164:167], a[164:167], v[84:87], v[164:167]
    v_exp_f32 v104, v104
    v_mfma_f32_16x16x32_bf16 v[168:171], a[136:139], v[80:83], v[168:171]
    v_exp_f32 v105, v105
    v_mfma_f32_16x16x32_bf16 v[168:171], a[168:171], v[84:87], v[168:171]
    ds_read_b128 a[84:87], v45 offset:36864
    v_exp_f32 v106, v106
    v_mfma_f32_16x16x32_bf16 v[172:175], a[140:143], v[80:83], v[172:175]
    v_exp_f32 v112, v112
    v_mfma_f32_16x16x32_bf16 v[172:175], a[172:175], v[84:87], v[172:175]
    ds_read_b64_tr_b16 a[218:219], v36 offset:53256
    v_cvt_pk_bf16_f32 v112, v112, v113
    v_mfma_f32_16x16x32_bf16 v[176:179], a[144:147], v[80:83], v[176:179]
    v_exp_f32 v123, v123
    v_mfma_f32_16x16x32_bf16 v[176:179], a[176:179], v[84:87], v[176:179]
    ds_read_b128 a[116:119], v45 offset:45056
    v_cvt_pk_bf16_f32 v101, v106, v107
    v_mfma_f32_16x16x32_bf16 v[180:183], a[148:151], v[80:83], v[180:183]
    ds_read_b64_tr_b16 a[248:249], v38 offset:49160
    v_cvt_pk_bf16_f32 v99, v102, v103
    v_mfma_f32_16x16x32_bf16 v[180:183], a[180:183], v[84:87], v[180:183]
    ds_read_b128 a[80:83], v44 offset:36864
    v_cvt_pk_bf16_f32 v100, v104, v105
    v_mfma_f32_16x16x32_bf16 v[184:187], a[152:155], v[80:83], v[184:187]
    v_exp_f32 v122, v122
    v_mfma_f32_16x16x32_bf16 v[184:187], a[184:187], v[84:87], v[184:187]
    ds_read_b128 a[124:127], v47 offset:45056
    v_cvt_pk_bf16_f32 v102, v108, v109
    v_mfma_f32_16x16x32_bf16 v[188:191], a[156:159], v[80:83], v[188:191]
    ds_read_b128 a[120:123], v46 offset:45056
    v_cvt_pk_bf16_f32 v103, v110, v111
    v_mfma_f32_16x16x32_bf16 v[188:191], a[188:191], v[84:87], v[188:191]
    v_exp_f32 v120, v120
    v_smfmac_f32_16x16x64_bf16 a[200:203], v[20:23], v[96:103], v29
    ds_read_b64_tr_b16 a[232:233], v37 offset:49160
    v_exp_f32 v115, v115
    v_mfma_f32_16x16x32_bf16 v[192:195], a[128:131], v[96:99], v[192:195]
    v_exp_f32 v124, v124
    v_mfma_f32_16x16x32_bf16 v[192:195], a[160:163], v[100:103], v[192:195]
    v_exp_f32 v119, v119
    v_mfma_f32_16x16x32_bf16 v[196:199], a[132:135], v[96:99], v[196:199]
    v_exp_f32 v117, v117
    v_mfma_f32_16x16x32_bf16 v[196:199], a[164:167], v[100:103], v[196:199]
    ds_read_b64_tr_b16 a[254:255], v38 offset:61448
    v_cvt_pk_bf16_f32 v113, v114, v115
    v_mfma_f32_16x16x32_bf16 v[200:203], a[136:139], v[96:99], v[200:203]
    v_exp_f32 v116, v116
    v_mfma_f32_16x16x32_bf16 v[200:203], a[168:171], v[100:103], v[200:203]
    v_exp_f32 v126, v126
    v_mfma_f32_16x16x32_bf16 v[204:207], a[140:143], v[96:99], v[204:207]
    ds_read_b64_tr_b16 a[240:241], v38 offset:49152
    v_cvt_pk_bf16_f32 v115, v118, v119
    v_mfma_f32_16x16x32_bf16 v[204:207], a[172:175], v[100:103], v[204:207]
    v_exp_f32 v127, v127
    v_mfma_f32_16x16x32_bf16 v[208:211], a[144:147], v[96:99], v[208:211]
    ds_read_b64_tr_b16 a[246:247], v38 offset:61440
    v_cvt_pk_bf16_f32 v114, v116, v117
    v_mfma_f32_16x16x32_bf16 v[208:211], a[176:179], v[100:103], v[208:211]
    v_exp_f32 v125, v125
    v_mfma_f32_16x16x32_bf16 v[212:215], a[148:151], v[96:99], v[212:215]
    ds_read_b128 a[64:67], v44 offset:32768
    v_cvt_pk_bf16_f32 v118, v124, v125
    v_mfma_f32_16x16x32_bf16 v[212:215], a[180:183], v[100:103], v[212:215]
    ds_read_b128 a[76:79], v47 offset:32768
    v_cvt_pk_bf16_f32 v117, v122, v123
    v_mfma_f32_16x16x32_bf16 v[216:219], a[152:155], v[96:99], v[216:219]
    ds_read_b64_tr_b16 a[234:235], v37 offset:53256
    v_cvt_pk_bf16_f32 v119, v126, v127
    v_mfma_f32_16x16x32_bf16 v[216:219], a[184:187], v[100:103], v[216:219]
    v_exp_f32 v121, v121
    v_mfma_f32_16x16x32_bf16 v[220:223], a[156:159], v[96:99], v[220:223]
    ds_read_b128 a[92:95], v47 offset:36864
    v_cvt_pk_bf16_f32 v116, v120, v121
    v_mfma_f32_16x16x32_bf16 v[220:223], a[188:191], v[100:103], v[220:223]
    ds_read_b128 a[96:99], v44 offset:40960
    v_smfmac_f32_16x16x64_bf16 a[204:207], v[20:23], v[112:119], v29
    ds_read_b64_tr_b16 a[224:225], v37 offset:49152
    v_mfma_f32_16x16x32_bf16 v[224:227], a[128:131], v[112:115], v[224:227]
    ds_read_b128 a[88:91], v46 offset:36864
    v_mfma_f32_16x16x32_bf16 v[224:227], a[160:163], v[116:119], v[224:227]
    s_waitcnt vmcnt(9)
    ds_read_b64_tr_b16 a[210:211], v36 offset:53248
    v_mfma_f32_16x16x32_bf16 v[228:231], a[132:135], v[112:115], v[228:231]
    ds_read_b64_tr_b16 a[228:229], v37 offset:57344
    v_mfma_f32_16x16x32_bf16 v[228:231], a[164:167], v[116:119], v[228:231]
    s_barrier
    v_mfma_f32_16x16x32_bf16 v[232:235], a[136:139], v[112:115], v[232:235]
    ds_read_b64_tr_b16 a[220:221], v36 offset:57352
    v_mfma_f32_16x16x32_bf16 v[232:235], a[168:171], v[116:119], v[232:235]
    ds_read_b64_tr_b16 a[212:213], v36 offset:57344
    v_mfma_f32_16x16x32_bf16 v[236:239], a[140:143], v[112:115], v[236:239]
    s_add_u32 s54, s52, L_s6-L_pc+4096
    ds_read_b64_tr_b16 a[128:129], v36 offset:32768
    v_mfma_f32_16x16x32_bf16 v[236:239], a[172:175], v[116:119], v[236:239]
    ds_read_b64_tr_b16 a[242:243], v38 offset:53248
    v_mfma_f32_16x16x32_bf16 v[240:243], a[144:147], v[112:115], v[240:243]
    ds_read_b64_tr_b16 a[168:169], v37 offset:40960
    v_mfma_f32_16x16x32_bf16 v[240:243], a[176:179], v[116:119], v[240:243]
    ds_read_b64_tr_b16 a[142:143], v37 offset:36872
    v_mfma_f32_16x16x32_bf16 v[244:247], a[148:151], v[112:115], v[244:247]
    s_addc_u32 s55, s53, 0
    ds_read_b64_tr_b16 a[148:149], v38 offset:32776
    v_mfma_f32_16x16x32_bf16 v[244:247], a[180:183], v[116:119], v[244:247]
    ds_read_b64_tr_b16 a[138:139], v37 offset:36864
    v_mfma_f32_16x16x32_bf16 v[248:251], a[152:155], v[112:115], v[248:251]
    global_load_dwordx4 v[40:43], v7, s[54:55]
    v_mfma_f32_16x16x32_bf16 v[248:251], a[184:187], v[116:119], v[248:251]
    ds_read_b64_tr_b16 a[136:137], v37 offset:32768
    v_mfma_f32_16x16x32_bf16 v[252:255], a[156:159], v[112:115], v[252:255]
    ds_read_b64_tr_b16 a[170:171], v37 offset:45056
    ds_read_b64_tr_b16 a[182:183], v38 offset:45064
    v_mfma_f32_16x16x32_bf16 v[252:255], a[188:191], v[116:119], v[252:255]
L_s6:
    s_waitcnt lgkmcnt(8)
    ds_read_b64_tr_b16 a[186:187], v39 offset:45056
    v_mfma_f32_16x16x32_bf16 v[64:67], a[64:67], a[0:3], v[48:51]
    ds_read_b64_tr_b16 a[172:173], v37 offset:40968
    v_mfma_f32_16x16x32_bf16 v[64:67], a[68:71], a[4:7], v[64:67]
    ds_read_b64_tr_b16 a[144:145], v38 offset:32768
    ds_read_b64_tr_b16 a[188:189], v39 offset:40968
    v_mfma_f32_16x16x32_bf16 v[64:67], a[72:75], a[8:11], v[64:67]
    ds_read_b64_tr_b16 a[158:159], v39 offset:36872
    v_mfma_f32_16x16x32_bf16 v[64:67], a[76:79], a[12:15], v[64:67]
    ds_read_b64_tr_b16 a[132:133], v36 offset:32776
    v_mfma_f32_16x16x32_bf16 v[68:71], a[80:83], a[0:3], v[48:51]
    ds_read_b64_tr_b16 a[150:151], v38 offset:36872
    v_mfma_f32_16x16x32_bf16 v[68:71], a[84:87], a[4:7], v[68:71]
    s_add_u32 m0, s44, 0x4000
    ds_read_b64_tr_b16 a[166:167], v36 offset:45064
    v_mfma_f32_16x16x32_bf16 v[68:71], a[88:91], a[8:11], v[68:71]
    buffer_load_dwordx4 v32, s[16:19], s37 offen offset:0 lds
    v_mfma_f32_16x16x32_bf16 v[68:71], a[92:95], a[12:15], v[68:71]
    ds_read_b64_tr_b16 a[162:163], v36 offset:45056
    v_mfma_f32_16x16x32_bf16 v[72:75], a[96:99], a[0:3], v[48:51]
    ds_read_b64_tr_b16 a[146:147], v38 offset:36864
    ds_read_b64_tr_b16 a[180:181], v38 offset:40968
    v_mfma_f32_16x16x32_bf16 v[72:75], a[100:103], a[4:7], v[72:75]
    ds_read_b64_tr_b16 a[190:191], v39 offset:45064
    v_exp_f32 v65, v65
    v_mfma_f32_16x16x32_bf16 v[72:75], a[104:107], a[8:11], v[72:75]
    v_exp_f32 v64, v64
    v_mfma_f32_16x16x32_bf16 v[72:75], a[108:111], a[12:15], v[72:75]
    ds_read_b64_tr_b16 a[134:135], v36 offset:36872
    v_cvt_pk_bf16_f32 v64, v64, v65
    v_mfma_f32_16x16x32_bf16 v[76:79], a[112:115], a[0:3], v[48:51]
    v_exp_f32 v66, v66
    v_mfma_f32_16x16x32_bf16 v[76:79], a[116:119], a[4:7], v[76:79]
    v_exp_f32 v67, v67
    v_mfma_f32_16x16x32_bf16 v[76:79], a[120:123], a[8:11], v[76:79]
    ds_read_b64_tr_b16 a[160:161], v36 offset:40960
    v_exp_f32 v68, v68
    v_mfma_f32_16x16x32_bf16 v[76:79], a[124:127], a[12:15], v[76:79]
    buffer_load_dwordx4 v33, s[16:19], s37 offen offset:1024 lds
    v_mfma_f32_16x16x32_bf16 v[80:83], a[64:67], a[16:19], v[52:55]
    v_exp_f32 v71, v71
    v_mfma_f32_16x16x32_bf16 v[80:83], a[68:71], a[20:23], v[80:83]
    ds_read_b64_tr_b16 a[164:165], v36 offset:40968
    ds_read_b64_tr_b16 a[174:175], v37 offset:45064
    v_mfma_f32_16x16x32_bf16 v[80:83], a[72:75], a[24:27], v[80:83]
    ds_read_b64_tr_b16 a[178:179], v38 offset:45056
    v_cvt_pk_bf16_f32 v65, v66, v67
    v_mfma_f32_16x16x32_bf16 v[80:83], a[76:79], a[28:31], v[80:83]
    ds_read_b64_tr_b16 a[250:251], v38 offset:53256
    v_exp_f32 v76, v76
    v_mfma_f32_16x16x32_bf16 v[84:87], a[80:83], a[16:19], v[52:55]
    v_exp_f32 v73, v73
    v_mfma_f32_16x16x32_bf16 v[84:87], a[84:87], a[20:23], v[84:87]
    ds_read_b64_tr_b16 a[154:155], v39 offset:36864
    v_exp_f32 v74, v74
    v_mfma_f32_16x16x32_bf16 v[84:87], a[88:91], a[24:27], v[84:87]
    v_exp_f32 v79, v79
    v_mfma_f32_16x16x32_bf16 v[84:87], a[92:95], a[28:31], v[84:87]
    buffer_load_dwordx4 v34, s[16:19], s37 offen offset:2048 lds
    v_mfma_f32_16x16x32_bf16 v[88:91], a[96:99], a[16:19], v[52:55]
    ds_read_b64_tr_b16 a[208:209], v36 offset:49152
    v_exp_f32 v69, v69
    v_mfma_f32_16x16x32_bf16 v[88:91], a[100:103], a[20:23], v[88:91]
    ds_read_b64_tr_b16 a[184:185], v39 offset:40960
    v_exp_f32 v77, v77
    v_mfma_f32_16x16x32_bf16 v[88:91], a[104:107], a[24:27], v[88:91]
    v_exp_f32 v72, v72
    v_mfma_f32_16x16x32_bf16 v[88:91], a[108:111], a[28:31], v[88:91]
    v_exp_f32 v82, v82
    v_mfma_f32_16x16x32_bf16 v[92:95], a[112:115], a[16:19], v[52:55]
    ds_read_b64_tr_b16 a[130:131], v36 offset:36864
    v_cvt_pk_bf16_f32 v66, v68, v69
    v_mfma_f32_16x16x32_bf16 v[92:95], a[116:119], a[20:23], v[92:95]
    v_exp_f32 v87, v87
    v_mfma_f32_16x16x32_bf16 v[92:95], a[120:123], a[24:27], v[92:95]
    buffer_load_dwordx4 v35, s[16:19], s37 offen offset:3072 lds
    v_mfma_f32_16x16x32_bf16 v[92:95], a[124:127], a[28:31], v[92:95]
    v_exp_f32 v89, v89
    v_mfma_f32_16x16x32_bf16 v[96:99], a[64:67], a[32:35], v[56:59]
    v_exp_f32 v75, v75
    v_mfma_f32_16x16x32_bf16 v[96:99], a[68:71], a[36:39], v[96:99]
    v_exp_f32 v84, v84
    v_mfma_f32_16x16x32_bf16 v[96:99], a[72:75], a[40:43], v[96:99]
    v_exp_f32 v80, v80
    v_mfma_f32_16x16x32_bf16 v[96:99], a[76:79], a[44:47], v[96:99]
    v_exp_f32 v83, v83
    v_mfma_f32_16x16x32_bf16 v[100:103], a[80:83], a[32:35], v[56:59]
    v_exp_f32 v70, v70
    v_mfma_f32_16x16x32_bf16 v[100:103], a[84:87], a[36:39], v[100:103]
    v_exp_f32 v95, v95
    v_mfma_f32_16x16x32_bf16 v[100:103], a[88:91], a[40:43], v[100:103]
    ds_read_b64_tr_b16 a[176:177], v38 offset:40960
    v_cvt_pk_bf16_f32 v69, v74, v75
    v_mfma_f32_16x16x32_bf16 v[100:103], a[92:95], a[44:47], v[100:103]
    s_add_u32 m0, s44, 0x14000
    v_exp_f32 v96, v96
    v_mfma_f32_16x16x32_bf16 v[104:107], a[96:99], a[32:35], v[56:59]
    buffer_load_dwordx4 v30, s[20:23], s37 offen offset:0 lds
    v_mfma_f32_16x16x32_bf16 v[104:107], a[100:103], a[36:39], v[104:107]
    ds_read_b64_tr_b16 a[156:157], v39 offset:32776
    v_cvt_pk_bf16_f32 v67, v70, v71
    v_mfma_f32_16x16x32_bf16 v[104:107], a[104:107], a[40:43], v[104:107]
    v_exp_f32 v91, v91
    v_mfma_f32_16x16x32_bf16 v[104:107], a[108:111], a[44:47], v[104:107]
    v_exp_f32 v92, v92
    v_mfma_f32_16x16x32_bf16 v[108:111], a[112:115], a[32:35], v[56:59]
    v_exp_f32 v85, v85
    v_mfma_f32_16x16x32_bf16 v[108:111], a[116:119], a[36:39], v[108:111]
    v_exp_f32 v93, v93
    v_mfma_f32_16x16x32_bf16 v[108:111], a[120:123], a[40:43], v[108:111]
    ds_read_b64_tr_b16 a[152:153], v39 offset:32768
    v_exp_f32 v78, v78
    v_mfma_f32_16x16x32_bf16 v[108:111], a[124:127], a[44:47], v[108:111]
    v_exp_f32 v81, v81
    v_mfma_f32_16x16x32_bf16 v[112:115], a[64:67], a[48:51], v[60:63]
    v_exp_f32 v100, v100
    v_mfma_f32_16x16x32_bf16 v[112:115], a[68:71], a[52:55], v[112:115]
    ds_read_b128 a[68:71], v45 offset:49152
    v_exp_f32 v86, v86
    v_mfma_f32_16x16x32_bf16 v[112:115], a[72:75], a[56:59], v[112:115]
    v_exp_f32 v99, v99
    v_mfma_f32_16x16x32_bf16 v[112:115], a[76:79], a[60:63], v[112:115]
    buffer_load_dwordx4 v30, s[20:23], s37 offen offset:1024 lds
    v_mfma_f32_16x16x32_bf16 v[116:119], a[80:83], a[48:51], v[60:63]
    ds_read_b128 a[72:75], v46 offset:49152
    v_cvt_pk_bf16_f32 v80, v80, v81
    v_mfma_f32_16x16x32_bf16 v[116:119], a[84:87], a[52:55], v[116:119]
    ds_read_b128 a[76:79], v47 offset:49152
    v_exp_f32 v102, v102
    v_mfma_f32_16x16x32_bf16 v[116:119], a[88:91], a[56:59], v[116:119]
    ds_read_b128 a[64:67], v44 offset:49152
    v_exp_f32 v97, v97
    v_mfma_f32_16x16x32_bf16 v[116:119], a[92:95], a[60:63], v[116:119]
    ds_read_b128 a[92:95], v47 offset:53248
    v_cvt_pk_bf16_f32 v96, v96, v97
    v_mfma_f32_16x16x32_bf16 v[120:123], a[96:99], a[48:51], v[60:63]
    ds_read_b128 a[88:91], v46 offset:53248
    v_cvt_pk_bf16_f32 v68, v72, v73
    v_mfma_f32_16x16x32_bf16 v[120:123], a[100:103], a[52:55], v[120:123]
    ds_read_b64_tr_b16 a[140:141], v37 offset:32776
    ds_read_b128 a[80:83], v44 offset:53248
    v_mfma_f32_16x16x32_bf16 v[120:123], a[104:107], a[56:59], v[120:123]
    buffer_load_dwordx4 v30, s[20:23], s37 offen offset:2048 lds
    v_mfma_f32_16x16x32_bf16 v[120:123], a[108:111], a[60:63], v[120:123]
    ds_read_b128 a[84:87], v45 offset:53248
    v_exp_f32 v113, v113
    v_mfma_f32_16x16x32_bf16 v[124:127], a[112:115], a[48:51], v[60:63]
    ds_read_b128 a[96:99], v44 offset:57344
    v_cvt_pk_bf16_f32 v71, v78, v79
    v_mfma_f32_16x16x32_bf16 v[124:127], a[116:119], a[52:55], v[124:127]
    ds_read_b128 a[104:107], v46 offset:57344
    v_cvt_pk_bf16_f32 v81, v82, v83
    v_mfma_f32_16x16x32_bf16 v[124:127], a[120:123], a[56:59], v[124:127]
    ds_read_b128 a[100:103], v45 offset:57344
    v_cvt_pk_bf16_f32 v70, v76, v77
    v_mfma_f32_16x16x32_bf16 v[124:127], a[124:127], a[60:63], v[124:127]
    ds_read_b128 a[120:123], v46 offset:61440
    v_cvt_pk_bf16_f32 v83, v86, v87
    v_smfmac_f32_16x16x64_bf16 a[192:195], v[20:23], v[64:71], v29
    s_waitcnt lgkmcnt(8)
    ds_read_b128 a[108:111], v47 offset:57344
    v_cvt_pk_bf16_f32 v86, v92, v93
    v_mfma_f32_16x16x32_bf16 v[128:131], a[128:131], v[64:67], v[128:131]
    ds_read_b128 a[116:119], v45 offset:61440
    v_cvt_pk_bf16_f32 v82, v84, v85
    v_mfma_f32_16x16x32_bf16 v[128:131], a[160:163], v[68:71], v[128:131]
    ds_read_b128 a[112:115], v44 offset:61440
    v_exp_f32 v104, v104
    v_mfma_f32_16x16x32_bf16 v[132:135], a[132:135], v[64:67], v[132:135]
    ds_read_b128 a[124:127], v47 offset:61440
    v_exp_f32 v112, v112
    v_mfma_f32_16x16x32_bf16 v[132:135], a[164:167], v[68:71], v[132:135]
    s_waitcnt lgkmcnt(7)
    v_exp_f32 v105, v105
    v_mfma_f32_16x16x32_bf16 v[136:139], a[136:139], v[64:67], v[136:139]
    buffer_load_dwordx4 v30, s[20:23], s37 offen offset:3072 lds
    v_mfma_f32_16x16x32_bf16 v[136:139], a[168:171], v[68:71], v[136:139]
    v_exp_f32 v108, v108
    v_mfma_f32_16x16x32_bf16 v[140:143], a[140:143], v[64:67], v[140:143]
    v_exp_f32 v107, v107
    v_mfma_f32_16x16x32_bf16 v[140:143], a[172:175], v[68:71], v[140:143]
    v_exp_f32 v90, v90
    v_mfma_f32_16x16x32_bf16 v[144:147], a[144:147], v[64:67], v[144:147]
    ds_read_b64_tr_b16 a[222:223], v36 offset:61448
    v_cvt_pk_bf16_f32 v85, v90, v91
    v_mfma_f32_16x16x32_bf16 v[144:147], a[176:179], v[68:71], v[144:147]
    v_exp_f32 v88, v88
    v_mfma_f32_16x16x32_bf16 v[148:151], a[148:151], v[64:67], v[148:151]
    v_exp_f32 v118, v118
    v_mfma_f32_16x16x32_bf16 v[148:151], a[180:183], v[68:71], v[148:151]
    v_exp_f32 v106, v106
    v_mfma_f32_16x16x32_bf16 v[152:155], a[152:155], v[64:67], v[152:155]
    v_exp_f32 v123, v123
    v_mfma_f32_16x16x32_bf16 v[152:155], a[184:187], v[68:71], v[152:155]
    v_exp_f32 v103, v103
    v_mfma_f32_16x16x32_bf16 v[156:159], a[156:159], v[64:67], v[156:159]
    v_exp_f32 v94, v94
    v_mfma_f32_16x16x32_bf16 v[156:159], a[188:191], v[68:71], v[156:159]
    v_exp_f32 v101, v101
    v_mfma_f32_16x16x32_bf16 v[64:67], a[64:67], a[0:3], v[48:51]
    v_exp_f32 v122, v122
    v_mfma_f32_16x16x32_bf16 v[64:67], a[68:71], a[4:7], v[64:67]
    v_exp_f32 v125, v125
    v_mfma_f32_16x16x32_bf16 v[64:67], a[72:75], a[8:11], v[64:67]
    ds_read_b64_tr_b16 a[252:253], v38 offset:57352
    v_cvt_pk_bf16_f32 v87, v94, v95
    v_mfma_f32_16x16x32_bf16 v[64:67], a[76:79], a[12:15], v[64:67]
    v_exp_f32 v98, v98
    v_mfma_f32_16x16x32_bf16 v[68:71], a[80:83], a[0:3], v[48:51]
    v_cvt_pk_bf16_f32 v84, v88, v89
    v_cvt_pk_bf16_f32 v97, v98, v99
    v_mfma_f32_16x16x32_bf16 v[68:71], a[84:87], a[4:7], v[68:71]
    s_waitcnt lgkmcnt(1)
    v_exp_f32 v111, v111
    v_mfma_f32_16x16x32_bf16 v[68:71], a[88:91], a[8:11], v[68:71]
    v_exp_f32 v121, v121
    v_mfma_f32_16x16x32_bf16 v[68:71], a[92:95], a[12:15], v[68:71]
    v_exp_f32 v64, v64
    v_mfma_f32_16x16x32_bf16 v[72:75], a[96:99], a[0:3], v[48:51]
    v_exp_f32 v67, v67
    v_mfma_f32_16x16x32_bf16 v[72:75], a[100:103], a[4:7], v[72:75]
    v_exp_f32 v110, v110
    v_mfma_f32_16x16x32_bf16 v[72:75], a[104:107], a[8:11], v[72:75]
    v_exp_f32 v114, v114
    v_mfma_f32_16x16x32_bf16 v[72:75], a[108:111], a[12:15], v[72:75]
    v_exp_f32 v66, v66
    v_mfma_f32_16x16x32_bf16 v[76:79], a[112:115], a[0:3], v[48:51]
    v_exp_f32 v68, v68
    v_mfma_f32_16x16x32_bf16 v[76:79], a[116:119], a[4:7], v[76:79]
    v_exp_f32 v71, v71
    v_mfma_f32_16x16x32_bf16 v[76:79], a[120:123], a[8:11], v[76:79]
    v_exp_f32 v70, v70
    v_mfma_f32_16x16x32_bf16 v[76:79], a[124:127], a[12:15], v[76:79]
    v_exp_f32 v73, v73
    v_smfmac_f32_16x16x64_bf16 a[196:199], v[20:23], v[80:87], v29
    ds_read_b64_tr_b16 a[2:3], v39 offset:53248
    v_exp_f32 v65, v65
    v_mfma_f32_16x16x32_bf16 v[160:163], a[128:131], v[80:83], v[160:163]
    v_exp_f32 v74, v74
    v_mfma_f32_16x16x32_bf16 v[160:163], a[160:163], v[84:87], v[160:163]
    v_exp_f32 v69, v69
    v_mfma_f32_16x16x32_bf16 v[164:167], a[132:135], v[80:83], v[164:167]
    ds_read_b64_tr_b16 a[12:13], v39 offset:57352
    v_cvt_pk_bf16_f32 v64, v64, v65
    v_mfma_f32_16x16x32_bf16 v[164:167], a[164:167], v[84:87], v[164:167]
    ds_read_b64_tr_b16 a[4:5], v39 offset:57344
    v_cvt_pk_bf16_f32 v65, v66, v67
    v_mfma_f32_16x16x32_bf16 v[168:171], a[136:139], v[80:83], v[168:171]
    v_exp_f32 v76, v76
    v_mfma_f32_16x16x32_bf16 v[168:171], a[168:171], v[84:87], v[168:171]
    v_exp_f32 v78, v78
    v_mfma_f32_16x16x32_bf16 v[172:175], a[140:143], v[80:83], v[172:175]
    v_exp_f32 v109, v109
    v_mfma_f32_16x16x32_bf16 v[172:175], a[172:175], v[84:87], v[172:175]
    v_exp_f32 v75, v75
    v_mfma_f32_16x16x32_bf16 v[176:179], a[144:147], v[80:83], v[176:179]
    v_exp_f32 v77, v77
    v_mfma_f32_16x16x32_bf16 v[176:179], a[176:179], v[84:87], v[176:179]
    v_exp_f32 v79, v79
    v_mfma_f32_16x16x32_bf16 v[180:183], a[148:151], v[80:83], v[180:183]
    v_exp_f32 v72, v72
    v_mfma_f32_16x16x32_bf16 v[180:183], a[180:183], v[84:87], v[180:183]
    v_cvt_pk_bf16_f32 v67, v70, v71
    v_cvt_pk_bf16_f32 v70, v76, v77
    v_mfma_f32_16x16x32_bf16 v[184:187], a[152:155], v[80:83], v[184:187]
    ds_read_b64_tr_b16 a[10:11], v39 offset:53256
    v_cvt_pk_bf16_f32 v66, v68, v69
    v_mfma_f32_16x16x32_bf16 v[184:187], a[184:187], v[84:87], v[184:187]
    v_cvt_pk_bf16_f32 v69, v74, v75
    v_cvt_pk_bf16_f32 v71, v78, v79
    v_mfma_f32_16x16x32_bf16 v[188:191], a[156:159], v[80:83], v[188:191]
    v_cvt_pk_bf16_f32 v99, v102, v103
    v_cvt_pk_bf16_f32 v68, v72, v73
    v_mfma_f32_16x16x32_bf16 v[188:191], a[188:191], v[84:87], v[188:191]
    ds_read_b64_tr_b16 a[14:15], v39 offset:61448
    v_cvt_pk_bf16_f32 v112, v112, v113
    v_smfmac_f32_16x16x64_bf16 a[192:195], v[20:23], v[64:71], v29
    ds_read_b64_tr_b16 a[6:7], v39 offset:61440
    v_exp_f32 v117, v117
    v_mfma_f32_16x16x32_bf16 v[128:131], a[208:211], v[64:67], v[128:131]
    ds_read_b64_tr_b16 a[8:9], v39 offset:49160
    v_cvt_pk_bf16_f32 v102, v108, v109
    v_mfma_f32_16x16x32_bf16 v[128:131], a[212:215], v[68:71], v[128:131]
    ds_read_b64_tr_b16 a[0:1], v39 offset:49152
    v_cvt_pk_bf16_f32 v103, v110, v111
    v_mfma_f32_16x16x32_bf16 v[132:135], a[216:219], v[64:67], v[132:135]
    v_exp_f32 v126, v126
    v_mfma_f32_16x16x32_bf16 v[132:135], a[220:223], v[68:71], v[132:135]
    v_accvgpr_read_b32 v10, a192
    v_accvgpr_read_b32 v12, a193
    v_add_f32 v10, v10, v12
    v_mfma_f32_16x16x32_bf16 v[136:139], a[224:227], v[64:67], v[136:139]
    v_rcp_f32 v11, v10
    v_mfma_f32_16x16x32_bf16 v[136:139], a[228:231], v[68:71], v[136:139]
    v_cmp_ngt_f32 vcc, 0x53800000, v10
    v_mul_f32 v128, v128, v11
    v_mfma_f32_16x16x32_bf16 v[140:143], a[232:235], v[64:67], v[140:143]
    v_mul_f32 v130, v130, v11
    v_mul_f32 v131, v131, v11
    v_mfma_f32_16x16x32_bf16 v[140:143], a[236:239], v[68:71], v[140:143]
    s_or_b64 s[46:47], s[46:47], vcc
    v_mul_f32 v129, v129, v11
    v_mul_f32 v132, v132, v11
    v_mul_f32 v133, v133, v11
    v_mul_f32 v134, v134, v11
    v_mul_f32 v135, v135, v11
    v_cvt_pk_bf16_f32 v128, v128, v129
    v_cvt_pk_bf16_f32 v129, v130, v131
    v_cvt_pk_bf16_f32 v130, v132, v133
    v_cvt_pk_bf16_f32 v131, v134, v135
    v_mfma_f32_16x16x32_bf16 v[144:147], a[240:243], v[64:67], v[144:147]
    buffer_store_dwordx4 v[128:131], v28, s[24:27], s30 offen offset:0 sc1 nt
    v_cvt_pk_bf16_f32 v98, v100, v101
    v_cvt_pk_bf16_f32 v100, v104, v105
    v_mfma_f32_16x16x32_bf16 v[144:147], a[244:247], v[68:71], v[144:147]
    s_waitcnt lgkmcnt(0)
    v_mul_f32 v136, v136, v11
    v_mul_f32 v139, v139, v11
    v_mfma_f32_16x16x32_bf16 v[148:151], a[248:251], v[64:67], v[148:151]
    v_mul_f32 v137, v137, v11
    v_mul_f32 v138, v138, v11
    v_mfma_f32_16x16x32_bf16 v[148:151], a[252:255], v[68:71], v[148:151]
    v_mul_f32 v141, v141, v11
    v_mul_f32 v142, v142, v11
    v_mul_f32 v143, v143, v11
    v_mfma_f32_16x16x32_bf16 v[152:155], a[0:3], v[64:67], v[152:155]
    v_mul_f32 v140, v140, v11
    v_cvt_pk_bf16_f32 v136, v136, v137
    v_cvt_pk_bf16_f32 v137, v138, v139
    v_cvt_pk_bf16_f32 v139, v142, v143
    v_mfma_f32_16x16x32_bf16 v[152:155], a[4:7], v[68:71], v[152:155]
    v_cvt_pk_bf16_f32 v138, v140, v141
    v_mul_f32 v146, v146, v11
    v_mfma_f32_16x16x32_bf16 v[156:159], a[8:11], v[64:67], v[156:159]
    buffer_store_dwordx4 v[136:139], v28, s[24:27], s30 offen offset:64 sc1 nt
    v_mul_f32 v144, v144, v11
    v_mul_f32 v147, v147, v11
    v_mfma_f32_16x16x32_bf16 v[156:159], a[12:15], v[68:71], v[156:159]
    v_mul_f32 v145, v145, v11
    v_mul_f32 v148, v148, v11
    v_mfma_f32_16x16x32_bf16 v[80:83], a[64:67], a[16:19], v[52:55]
    v_mul_f32 v149, v149, v11
    v_cvt_pk_bf16_f32 v144, v144, v145
    v_mfma_f32_16x16x32_bf16 v[80:83], a[68:71], a[20:23], v[80:83]
    v_mul_f32 v150, v150, v11
    v_mul_f32 v151, v151, v11
    v_mfma_f32_16x16x32_bf16 v[80:83], a[72:75], a[24:27], v[80:83]
    v_cvt_pk_bf16_f32 v145, v146, v147
    v_cvt_pk_bf16_f32 v146, v148, v149
    v_mfma_f32_16x16x32_bf16 v[80:83], a[76:79], a[28:31], v[80:83]
    v_cvt_pk_bf16_f32 v101, v106, v107
    v_cvt_pk_bf16_f32 v147, v150, v151
    v_mfma_f32_16x16x32_bf16 v[84:87], a[80:83], a[16:19], v[52:55]
    buffer_store_dwordx4 v[144:147], v28, s[24:27], s30 offen offset:128 sc1 nt
    v_mul_f32 v153, v153, v11
    v_mul_f32 v156, v156, v11
    v_mfma_f32_16x16x32_bf16 v[84:87], a[84:87], a[20:23], v[84:87]
    v_mul_f32 v152, v152, v11
    v_mul_f32 v155, v155, v11
    v_mfma_f32_16x16x32_bf16 v[84:87], a[88:91], a[24:27], v[84:87]
    v_mul_f32 v154, v154, v11
    v_mul_f32 v157, v157, v11
    v_mfma_f32_16x16x32_bf16 v[84:87], a[92:95], a[28:31], v[84:87]
    v_mul_f32 v159, v159, v11
    v_cvt_pk_bf16_f32 v152, v152, v153
    v_mfma_f32_16x16x32_bf16 v[88:91], a[96:99], a[16:19], v[52:55]
    v_cvt_pk_bf16_f32 v153, v154, v155
    v_cvt_pk_bf16_f32 v154, v156, v157
    v_mfma_f32_16x16x32_bf16 v[88:91], a[100:103], a[20:23], v[88:91]
    s_waitcnt vmcnt(12)
    v_mul_f32 v158, v158, v11
    v_cvt_pk_bf16_f32 v155, v158, v159
    v_mfma_f32_16x16x32_bf16 v[88:91], a[104:107], a[24:27], v[88:91]
    buffer_store_dwordx4 v[152:155], v28, s[24:27], s30 offen offset:192 sc1 nt
    v_exp_f32 v80, v80
    v_mfma_f32_16x16x32_bf16 v[88:91], a[108:111], a[28:31], v[88:91]
    v_exp_f32 v87, v87
    v_mfma_f32_16x16x32_bf16 v[92:95], a[112:115], a[16:19], v[52:55]
    v_exp_f32 v86, v86
    v_mfma_f32_16x16x32_bf16 v[92:95], a[116:119], a[20:23], v[92:95]
    v_exp_f32 v85, v85
    v_mfma_f32_16x16x32_bf16 v[92:95], a[120:123], a[24:27], v[92:95]
    v_exp_f32 v82, v82
    v_mfma_f32_16x16x32_bf16 v[92:95], a[124:127], a[28:31], v[92:95]
    v_exp_f32 v90, v90
    v_smfmac_f32_16x16x64_bf16 a[200:203], v[20:23], v[96:103], v29
    v_exp_f32 v83, v83
    v_mfma_f32_16x16x32_bf16 v[192:195], a[128:131], v[96:99], v[192:195]
    v_exp_f32 v84, v84
    v_mfma_f32_16x16x32_bf16 v[192:195], a[160:163], v[100:103], v[192:195]
    v_exp_f32 v115, v115
    v_mfma_f32_16x16x32_bf16 v[196:199], a[132:135], v[96:99], v[196:199]
    v_exp_f32 v116, v116
    v_mfma_f32_16x16x32_bf16 v[196:199], a[164:167], v[100:103], v[196:199]
    v_exp_f32 v81, v81
    v_mfma_f32_16x16x32_bf16 v[200:203], a[136:139], v[96:99], v[200:203]
    v_exp_f32 v88, v88
    v_mfma_f32_16x16x32_bf16 v[200:203], a[168:171], v[100:103], v[200:203]
    v_exp_f32 v92, v92
    v_mfma_f32_16x16x32_bf16 v[204:207], a[140:143], v[96:99], v[204:207]
    v_cvt_pk_bf16_f32 v80, v80, v81
    v_cvt_pk_bf16_f32 v81, v82, v83
    v_mfma_f32_16x16x32_bf16 v[204:207], a[172:175], v[100:103], v[204:207]
    v_exp_f32 v89, v89
    v_mfma_f32_16x16x32_bf16 v[208:211], a[144:147], v[96:99], v[208:211]
    v_exp_f32 v91, v91
    v_mfma_f32_16x16x32_bf16 v[208:211], a[176:179], v[100:103], v[208:211]
    v_exp_f32 v95, v95
    v_mfma_f32_16x16x32_bf16 v[212:215], a[148:151], v[96:99], v[212:215]
    v_exp_f32 v94, v94
    v_mfma_f32_16x16x32_bf16 v[212:215], a[180:183], v[100:103], v[212:215]
    v_cvt_pk_bf16_f32 v82, v84, v85
    v_cvt_pk_bf16_f32 v85, v90, v91
    v_mfma_f32_16x16x32_bf16 v[216:219], a[152:155], v[96:99], v[216:219]
    v_cvt_pk_bf16_f32 v83, v86, v87
    v_cvt_pk_bf16_f32 v84, v88, v89
    v_mfma_f32_16x16x32_bf16 v[216:219], a[184:187], v[100:103], v[216:219]
    v_exp_f32 v93, v93
    v_mfma_f32_16x16x32_bf16 v[220:223], a[156:159], v[96:99], v[220:223]
    v_cvt_pk_bf16_f32 v86, v92, v93
    v_cvt_pk_bf16_f32 v87, v94, v95
    v_mfma_f32_16x16x32_bf16 v[220:223], a[188:191], v[100:103], v[220:223]
    v_exp_f32 v119, v119
    v_smfmac_f32_16x16x64_bf16 a[196:199], v[20:23], v[80:87], v29
    s_barrier
    v_mfma_f32_16x16x32_bf16 v[160:163], a[208:211], v[80:83], v[160:163]
    v_exp_f32 v127, v127
    v_mfma_f32_16x16x32_bf16 v[160:163], a[212:215], v[84:87], v[160:163]
    v_exp_f32 v120, v120
    v_mfma_f32_16x16x32_bf16 v[164:167], a[216:219], v[80:83], v[164:167]
    v_cvt_pk_bf16_f32 v113, v114, v115
    v_cvt_pk_bf16_f32 v114, v116, v117
    v_mfma_f32_16x16x32_bf16 v[164:167], a[220:223], v[84:87], v[164:167]
    v_accvgpr_read_b32 v13, a196
    v_accvgpr_read_b32 v15, a197
    v_add_f32 v13, v13, v15
    v_mfma_f32_16x16x32_bf16 v[168:171], a[224:227], v[80:83], v[168:171]
    v_rcp_f32 v14, v13
    v_cmp_ngt_f32 vcc, 0x53800000, v13
    v_mfma_f32_16x16x32_bf16 v[168:171], a[228:231], v[84:87], v[168:171]
    v_mul_f32 v161, v161, v14
    s_or_b64 s[46:47], s[46:47], vcc
    v_mul_f32 v163, v163, v14
    v_mfma_f32_16x16x32_bf16 v[172:175], a[232:235], v[80:83], v[172:175]
    v_mul_f32 v160, v160, v14
    v_mul_f32 v162, v162, v14
    v_cvt_pk_bf16_f32 v160, v160, v161
    v_cvt_pk_bf16_f32 v161, v162, v163
    v_mfma_f32_16x16x32_bf16 v[172:175], a[236:239], v[84:87], v[172:175]
    s_waitcnt vmcnt(4)
    v_mul_f32 v164, v164, v14
    v_mul_f32 v165, v165, v14
    v_mul_f32 v166, v166, v14
    v_mul_f32 v167, v167, v14
    v_cvt_pk_bf16_f32 v162, v164, v165
    v_cvt_pk_bf16_f32 v163, v166, v167
    v_mfma_f32_16x16x32_bf16 v[176:179], a[240:243], v[80:83], v[176:179]
    buffer_store_dwordx4 v[160:163], v28, s[24:27], s31 offen offset:0 sc1 nt
    v_cvt_pk_bf16_f32 v115, v118, v119
    v_cvt_pk_bf16_f32 v119, v126, v127
    v_mfma_f32_16x16x32_bf16 v[176:179], a[244:247], v[84:87], v[176:179]
L_pg4:
    s_cbranch_execz L_pgret4
    v_mul_f32 v168, v168, v14
    v_mul_f32 v169, v169, v14
    v_mfma_f32_16x16x32_bf16 v[180:183], a[248:251], v[80:83], v[180:183]
    v_mul_f32 v170, v170, v14
    v_mul_f32 v171, v171, v14
    v_cvt_pk_bf16_f32 v168, v168, v169
    v_mfma_f32_16x16x32_bf16 v[180:183], a[252:255], v[84:87], v[180:183]
    v_mul_f32 v172, v172, v14
    v_mul_f32 v173, v173, v14
    v_mfma_f32_16x16x32_bf16 v[184:187], a[0:3], v[80:83], v[184:187]
    s_barrier
    v_mul_f32 v174, v174, v14
    v_mul_f32 v175, v175, v14
    v_mfma_f32_16x16x32_bf16 v[184:187], a[4:7], v[84:87], v[184:187]
    v_cvt_pk_bf16_f32 v169, v170, v171
    v_cvt_pk_bf16_f32 v170, v172, v173
    v_cvt_pk_bf16_f32 v171, v174, v175
    v_mfma_f32_16x16x32_bf16 v[188:191], a[8:11], v[80:83], v[188:191]
    buffer_store_dwordx4 v[168:171], v28, s[24:27], s31 offen offset:64 sc1 nt
    v_mul_f32 v177, v177, v14
    v_mul_f32 v179, v179, v14
    v_mfma_f32_16x16x32_bf16 v[188:191], a[12:15], v[84:87], v[188:191]
    ds_read_b64_tr_b16 v[130:131], v36 offset:20480
    v_mul_f32 v178, v178, v14
    v_mul_f32 v180, v180, v14
    v_mfma_f32_16x16x32_bf16 v[96:99], a[64:67], a[32:35], v[56:59]
    v_mul_f32 v176, v176, v14
    v_cvt_pk_bf16_f32 v176, v176, v177
    v_mfma_f32_16x16x32_bf16 v[96:99], a[68:71], a[36:39], v[96:99]
    v_mul_f32 v183, v183, v14
    v_cvt_pk_bf16_f32 v177, v178, v179
    v_mfma_f32_16x16x32_bf16 v[96:99], a[72:75], a[40:43], v[96:99]
    ds_read_b64_tr_b16 v[150:151], v38 offset:20488
    v_mul_f32 v182, v182, v14
    v_mul_f32 v185, v185, v14
    v_mfma_f32_16x16x32_bf16 v[96:99], a[76:79], a[44:47], v[96:99]
    v_mul_f32 v181, v181, v14
    v_cvt_pk_bf16_f32 v178, v180, v181
    v_cvt_pk_bf16_f32 v179, v182, v183
    v_mfma_f32_16x16x32_bf16 v[100:103], a[80:83], a[32:35], v[56:59]
    buffer_store_dwordx4 v[176:179], v28, s[24:27], s31 offen offset:128 sc1 nt
    v_mul_f32 v184, v184, v14
    v_mul_f32 v186, v186, v14
    v_mul_f32 v190, v190, v14
    v_cvt_pk_bf16_f32 v184, v184, v185
    v_mfma_f32_16x16x32_bf16 v[100:103], a[84:87], a[36:39], v[100:103]
    ds_read_b64_tr_b16 v[170:171], v37 offset:28672
    v_mul_f32 v188, v188, v14
    v_mfma_f32_16x16x32_bf16 v[100:103], a[88:91], a[40:43], v[100:103]
    ds_read_b64_tr_b16 v[182:183], v38 offset:28680
    v_mul_f32 v187, v187, v14
    v_mfma_f32_16x16x32_bf16 v[100:103], a[92:95], a[44:47], v[100:103]
    ds_read_b64_tr_b16 v[160:161], v36 offset:24576
    v_cvt_pk_bf16_f32 v185, v186, v187
    v_mfma_f32_16x16x32_bf16 v[104:107], a[96:99], a[32:35], v[56:59]
    ds_read_b64_tr_b16 v[142:143], v37 offset:20488
    v_mul_f32 v189, v189, v14
    v_cvt_pk_bf16_f32 v186, v188, v189
    v_mfma_f32_16x16x32_bf16 v[104:107], a[100:103], a[36:39], v[104:107]
    ds_read_b64_tr_b16 v[166:167], v36 offset:28680
    v_mul_f32 v191, v191, v14
    v_cvt_pk_bf16_f32 v187, v190, v191
    v_mfma_f32_16x16x32_bf16 v[104:107], a[104:107], a[40:43], v[104:107]
    buffer_store_dwordx4 v[184:187], v28, s[24:27], s31 offen offset:192 sc1 nt
    v_exp_f32 v99, v99
    v_mfma_f32_16x16x32_bf16 v[104:107], a[108:111], a[44:47], v[104:107]
    ds_read_b64_tr_b16 v[174:175], v37 offset:28680
    v_cvt_pk_bf16_f32 v117, v122, v123
    v_mfma_f32_16x16x32_bf16 v[108:111], a[112:115], a[32:35], v[56:59]
    v_exp_f32 v124, v124
    v_mfma_f32_16x16x32_bf16 v[108:111], a[116:119], a[36:39], v[108:111]
    ds_read_b64_tr_b16 v[128:129], v36 offset:16384
    v_cvt_pk_bf16_f32 v116, v120, v121
    v_mfma_f32_16x16x32_bf16 v[108:111], a[120:123], a[40:43], v[108:111]
    ds_read_b64_tr_b16 v[178:179], v38 offset:28672
    v_cvt_pk_bf16_f32 v118, v124, v125
    v_mfma_f32_16x16x32_bf16 v[108:111], a[124:127], a[44:47], v[108:111]
    v_exp_f32 v103, v103
    v_smfmac_f32_16x16x64_bf16 a[204:207], v[20:23], v[112:119], v29
    ds_read_b64_tr_b16 v[138:139], v37 offset:20480
    v_mfma_f32_16x16x32_bf16 v[224:227], a[128:131], v[112:115], v[224:227]
    v_exp_f32 v101, v101
    v_mfma_f32_16x16x32_bf16 v[224:227], a[160:163], v[116:119], v[224:227]
    v_exp_f32 v98, v98
    v_mfma_f32_16x16x32_bf16 v[228:231], a[132:135], v[112:115], v[228:231]
    ds_read_b64_tr_b16 a[130:131], v36 offset:4096
    v_exp_f32 v106, v106
    v_mfma_f32_16x16x32_bf16 v[228:231], a[164:167], v[116:119], v[228:231]
    ds_read_b64_tr_b16 v[172:173], v37 offset:24584
    v_mfma_f32_16x16x32_bf16 v[232:235], a[136:139], v[112:115], v[232:235]
    v_exp_f32 v107, v107
    v_mfma_f32_16x16x32_bf16 v[232:235], a[168:171], v[116:119], v[232:235]
    ds_read_b64_tr_b16 a[134:135], v36 offset:4104
    v_exp_f32 v110, v110
    v_mfma_f32_16x16x32_bf16 v[236:239], a[140:143], v[112:115], v[236:239]
    v_exp_f32 v97, v97
    v_mfma_f32_16x16x32_bf16 v[236:239], a[172:175], v[116:119], v[236:239]
    ds_read_b64_tr_b16 a[166:167], v36 offset:12296
    v_mfma_f32_16x16x32_bf16 v[240:243], a[144:147], v[112:115], v[240:243]
    ds_read_b64_tr_b16 a[142:143], v37 offset:4104
    v_exp_f32 v111, v111
    v_mfma_f32_16x16x32_bf16 v[240:243], a[176:179], v[116:119], v[240:243]
    v_exp_f32 v100, v100
    v_mfma_f32_16x16x32_bf16 v[244:247], a[148:151], v[112:115], v[244:247]
    ds_read_b64_tr_b16 a[148:149], v38 offset:8
    v_exp_f32 v96, v96
    v_mfma_f32_16x16x32_bf16 v[244:247], a[180:183], v[116:119], v[244:247]
    ds_read_b64_tr_b16 a[168:169], v37 offset:8192
    v_exp_f32 v109, v109
    v_mfma_f32_16x16x32_bf16 v[248:251], a[152:155], v[112:115], v[248:251]
    v_exp_f32 v108, v108
    v_mfma_f32_16x16x32_bf16 v[248:251], a[184:187], v[116:119], v[248:251]
    ds_read_b64_tr_b16 a[128:129], v36 offset:0
    v_mfma_f32_16x16x32_bf16 v[252:255], a[156:159], v[112:115], v[252:255]
    ds_read_b64_tr_b16 v[158:159], v39 offset:20488
    v_exp_f32 v104, v104
    v_mfma_f32_16x16x32_bf16 v[252:255], a[188:191], v[116:119], v[252:255]
    ds_read_b64_tr_b16 a[172:173], v37 offset:8200
    ds_read_b64_tr_b16 v[168:169], v37 offset:24576
    v_mfma_f32_16x16x32_bf16 v[112:115], a[64:67], a[48:51], v[60:63]
    ds_read_b64_tr_b16 a[180:181], v38 offset:8200
    v_cvt_pk_bf16_f32 v96, v96, v97
    v_mfma_f32_16x16x32_bf16 v[112:115], a[68:71], a[52:55], v[112:115]
    ds_read_b64_tr_b16 a[158:159], v39 offset:4104
    v_exp_f32 v102, v102
    v_mfma_f32_16x16x32_bf16 v[112:115], a[72:75], a[56:59], v[112:115]
    ds_read_b64_tr_b16 v[148:149], v38 offset:16392
    v_mfma_f32_16x16x32_bf16 v[112:115], a[76:79], a[60:63], v[112:115]
    ds_read_b64_tr_b16 a[144:145], v38 offset:0
    v_cvt_pk_bf16_f32 v97, v98, v99
    v_mfma_f32_16x16x32_bf16 v[116:119], a[80:83], a[48:51], v[60:63]
    ds_read_b64_tr_b16 a[186:187], v39 offset:12288
    v_exp_f32 v105, v105
    v_mfma_f32_16x16x32_bf16 v[116:119], a[84:87], a[52:55], v[116:119]
    ds_read_b64_tr_b16 a[132:133], v36 offset:8
    v_cvt_pk_bf16_f32 v98, v100, v101
    v_mfma_f32_16x16x32_bf16 v[116:119], a[88:91], a[56:59], v[116:119]
    ds_read_b64_tr_b16 a[154:155], v39 offset:4096
    ds_read_b64_tr_b16 a[170:171], v37 offset:12288
    v_mfma_f32_16x16x32_bf16 v[116:119], a[92:95], a[60:63], v[116:119]
    ds_read_b128 a[68:71], v45 offset:0
    v_exp_f32 v115, v115
    v_mfma_f32_16x16x32_bf16 v[120:123], a[96:99], a[48:51], v[60:63]
    ds_read_b64_tr_b16 a[136:137], v37 offset:0
    v_exp_f32 v114, v114
    v_mfma_f32_16x16x32_bf16 v[120:123], a[100:103], a[52:55], v[120:123]
    ds_read_b64_tr_b16 a[160:161], v36 offset:8192
    v_cvt_pk_bf16_f32 v99, v102, v103
    v_mfma_f32_16x16x32_bf16 v[120:123], a[104:107], a[56:59], v[120:123]
    ds_read_b64_tr_b16 a[190:191], v39 offset:12296
    v_cvt_pk_bf16_f32 v101, v106, v107
    v_mfma_f32_16x16x32_bf16 v[120:123], a[108:111], a[60:63], v[120:123]
    ds_read_b64_tr_b16 a[150:151], v38 offset:4104
    v_cvt_pk_bf16_f32 v100, v104, v105
    v_mfma_f32_16x16x32_bf16 v[124:127], a[112:115], a[48:51], v[60:63]
    ds_read_b128 a[72:75], v46 offset:0
    v_mfma_f32_16x16x32_bf16 v[124:127], a[116:119], a[52:55], v[124:127]
    ds_read_b64_tr_b16 a[164:165], v36 offset:8200
    v_cvt_pk_bf16_f32 v103, v110, v111
    v_mfma_f32_16x16x32_bf16 v[124:127], a[120:123], a[56:59], v[124:127]
    ds_read_b64_tr_b16 a[178:179], v38 offset:12288
    v_cvt_pk_bf16_f32 v102, v108, v109
    v_mfma_f32_16x16x32_bf16 v[124:127], a[124:127], a[60:63], v[124:127]
    ds_read_b128 a[64:67], v44 offset:0
    ds_read_b128 a[80:83], v44 offset:4096
    v_smfmac_f32_16x16x64_bf16 a[200:203], v[20:23], v[96:103], v29
    ds_read_b128 a[96:99], v44 offset:8192
    ds_read_b128 a[112:115], v44 offset:12288
    v_mfma_f32_16x16x32_bf16 v[192:195], a[208:211], v[96:99], v[192:195]
    ds_read_b64_tr_b16 a[176:177], v38 offset:8192
    ds_read_b128 a[76:79], v47 offset:0
    v_mfma_f32_16x16x32_bf16 v[192:195], a[212:215], v[100:103], v[192:195]
    ds_read_b64_tr_b16 v[132:133], v36 offset:16392
    v_mfma_f32_16x16x32_bf16 v[196:199], a[216:219], v[96:99], v[196:199]
    ds_read_b128 a[104:107], v46 offset:8192
    v_exp_f32 v124, v124
    v_mfma_f32_16x16x32_bf16 v[196:199], a[220:223], v[100:103], v[196:199]
    ds_read_b128 a[108:111], v47 offset:8192
    v_exp_f32 v113, v113
    v_mfma_f32_16x16x32_bf16 v[200:203], a[224:227], v[96:99], v[200:203]
    ds_read_b128 a[124:127], v47 offset:12288
    v_mfma_f32_16x16x32_bf16 v[200:203], a[228:231], v[100:103], v[200:203]
    ds_read_b128 a[84:87], v45 offset:4096
    ds_read_b128 a[116:119], v45 offset:12288
    v_mfma_f32_16x16x32_bf16 v[204:207], a[232:235], v[96:99], v[204:207]
    v_exp_f32 v117, v117
    v_mfma_f32_16x16x32_bf16 v[204:207], a[236:239], v[100:103], v[204:207]
    ds_read_b64_tr_b16 a[138:139], v37 offset:4096
    v_mfma_f32_16x16x32_bf16 v[208:211], a[240:243], v[96:99], v[208:211]
    ds_read_b128 a[100:103], v45 offset:8192
    v_exp_f32 v112, v112
    v_mfma_f32_16x16x32_bf16 v[208:211], a[244:247], v[100:103], v[208:211]
    ds_read_b64_tr_b16 a[188:189], v39 offset:8200
    v_exp_f32 v120, v120
    v_mfma_f32_16x16x32_bf16 v[212:215], a[248:251], v[96:99], v[212:215]
    ds_read_b128 a[92:95], v47 offset:4096
    v_cvt_pk_bf16_f32 v112, v112, v113
    v_mfma_f32_16x16x32_bf16 v[212:215], a[252:255], v[100:103], v[212:215]
    ds_read_b128 a[88:91], v46 offset:4096
    v_mfma_f32_16x16x32_bf16 v[216:219], a[0:3], v[96:99], v[216:219]
    s_waitcnt lgkmcnt(7)
    v_exp_f32 v121, v121
    v_mfma_f32_16x16x32_bf16 v[216:219], a[4:7], v[100:103], v[216:219]
    v_exp_f32 v119, v119
    v_mfma_f32_16x16x32_bf16 v[220:223], a[8:11], v[96:99], v[220:223]
    v_exp_f32 v116, v116
    v_mfma_f32_16x16x32_bf16 v[220:223], a[12:15], v[100:103], v[220:223]
    ds_read_b64_tr_b16 a[156:157], v39 offset:8
    v_cvt_pk_bf16_f32 v113, v114, v115
    v_mfma_f32_16x16x32_bf16 v[96:99], a[64:67], a[32:35], v[56:59]
    v_exp_f32 v123, v123
    v_mfma_f32_16x16x32_bf16 v[96:99], a[68:71], a[36:39], v[96:99]
    ds_read_b64_tr_b16 a[152:153], v39 offset:0
    v_cvt_pk_bf16_f32 v114, v116, v117
    v_mfma_f32_16x16x32_bf16 v[96:99], a[72:75], a[40:43], v[96:99]
    ds_read_b64_tr_b16 a[140:141], v37 offset:8
    v_cvt_pk_bf16_f32 v116, v120, v121
    v_mfma_f32_16x16x32_bf16 v[96:99], a[76:79], a[44:47], v[96:99]
    ds_read_b128 a[120:123], v46 offset:12288
    v_exp_f32 v125, v125
    v_mfma_f32_16x16x32_bf16 v[100:103], a[80:83], a[32:35], v[56:59]
    s_waitcnt lgkmcnt(4)
    v_exp_f32 v126, v126
    v_mfma_f32_16x16x32_bf16 v[100:103], a[84:87], a[36:39], v[100:103]
    v_exp_f32 v122, v122
    v_mfma_f32_16x16x32_bf16 v[100:103], a[88:91], a[40:43], v[100:103]
    v_exp_f32 v118, v118
    v_mfma_f32_16x16x32_bf16 v[100:103], a[92:95], a[44:47], v[100:103]
    ds_read_b64_tr_b16 a[146:147], v38 offset:4096
    v_exp_f32 v97, v97
    v_mfma_f32_16x16x32_bf16 v[104:107], a[96:99], a[32:35], v[56:59]
    v_exp_f32 v98, v98
    v_mfma_f32_16x16x32_bf16 v[104:107], a[100:103], a[36:39], v[104:107]
    v_exp_f32 v96, v96
    v_mfma_f32_16x16x32_bf16 v[104:107], a[104:107], a[40:43], v[104:107]
    v_exp_f32 v99, v99
    v_cvt_pk_bf16_f32 v96, v96, v97
    v_mfma_f32_16x16x32_bf16 v[104:107], a[108:111], a[44:47], v[104:107]
    ds_read_b64_tr_b16 v[136:137], v37 offset:16384
    v_exp_f32 v101, v101
    v_mfma_f32_16x16x32_bf16 v[108:111], a[112:115], a[32:35], v[56:59]
    s_waitcnt lgkmcnt(2)
    v_exp_f32 v100, v100
    v_exp_f32 v103, v103
    v_mfma_f32_16x16x32_bf16 v[108:111], a[116:119], a[36:39], v[108:111]
    ds_read_b64_tr_b16 a[162:163], v36 offset:12288
    v_exp_f32 v102, v102
    v_cvt_pk_bf16_f32 v97, v98, v99
    v_mfma_f32_16x16x32_bf16 v[108:111], a[120:123], a[40:43], v[108:111]
    ds_read_b64_tr_b16 a[182:183], v38 offset:12296
    v_cvt_pk_bf16_f32 v98, v100, v101
    v_cvt_pk_bf16_f32 v99, v102, v103
    v_mfma_f32_16x16x32_bf16 v[108:111], a[124:127], a[44:47], v[108:111]
    ds_read_b64_tr_b16 a[184:185], v39 offset:8192
    v_exp_f32 v106, v106
    v_mfma_f32_16x16x32_bf16 v[192:195], a[128:131], v[96:99], v[192:195]
    ds_read_b64_tr_b16 v[144:145], v38 offset:16384
    v_exp_f32 v107, v107
    v_mfma_f32_16x16x32_bf16 v[196:199], a[132:135], v[96:99], v[196:199]
    s_waitcnt lgkmcnt(5)
    v_exp_f32 v104, v104
    v_exp_f32 v105, v105
    v_mfma_f32_16x16x32_bf16 v[200:203], a[136:139], v[96:99], v[200:203]
    ds_read_b64_tr_b16 a[174:175], v37 offset:12296
    v_cvt_pk_bf16_f32 v101, v106, v107
    v_mfma_f32_16x16x32_bf16 v[204:207], a[140:143], v[96:99], v[204:207]
    v_exp_f32 v111, v111
    v_mfma_f32_16x16x32_bf16 v[208:211], a[144:147], v[96:99], v[208:211]
    v_exp_f32 v109, v109
    v_exp_f32 v110, v110
    v_mfma_f32_16x16x32_bf16 v[212:215], a[148:151], v[96:99], v[212:215]
    s_waitcnt lgkmcnt(3)
    v_exp_f32 v108, v108
    v_cvt_pk_bf16_f32 v100, v104, v105
    v_mfma_f32_16x16x32_bf16 v[216:219], a[152:155], v[96:99], v[216:219]
    v_cvt_pk_bf16_f32 v102, v108, v109
    v_cvt_pk_bf16_f32 v103, v110, v111
    v_mfma_f32_16x16x32_bf16 v[220:223], a[156:159], v[96:99], v[220:223]
    v_exp_f32 v127, v127
    v_smfmac_f32_16x16x64_bf16 a[200:203], v[20:23], v[96:103], v29
    ds_read_b64_tr_b16 v[188:189], v39 offset:24584
    v_cvt_pk_bf16_f32 v115, v118, v119
    v_mfma_f32_16x16x32_bf16 v[192:195], a[160:163], v[100:103], v[192:195]
    ds_read_b64_tr_b16 v[146:147], v38 offset:20480
    v_cvt_pk_bf16_f32 v119, v126, v127
    v_mfma_f32_16x16x32_bf16 v[196:199], a[164:167], v[100:103], v[196:199]
    ds_read_b64_tr_b16 v[180:181], v38 offset:24584
    v_cvt_pk_bf16_f32 v118, v124, v125
    v_mfma_f32_16x16x32_bf16 v[200:203], a[168:171], v[100:103], v[200:203]
    s_waitcnt lgkmcnt(3)
    ds_read_b64_tr_b16 v[140:141], v37 offset:16392
    v_cvt_pk_bf16_f32 v117, v122, v123
    v_mfma_f32_16x16x32_bf16 v[204:207], a[172:175], v[100:103], v[204:207]
    v_accvgpr_read_b32 v8, a200
    v_accvgpr_read_b32 v10, a201
    v_add_f32 v8, v8, v10
    v_rcp_f32 v9, v8
    v_mfma_f32_16x16x32_bf16 v[208:211], a[176:179], v[100:103], v[208:211]
    v_cmp_ngt_f32 vcc, 0x53800000, v8
    v_mul_f32 v193, v193, v9
    v_mfma_f32_16x16x32_bf16 v[212:215], a[180:183], v[100:103], v[212:215]
    s_or_b64 s[46:47], s[46:47], vcc
    v_mul_f32 v195, v195, v9
    v_mul_f32 v199, v199, v9
    v_mfma_f32_16x16x32_bf16 v[216:219], a[184:187], v[100:103], v[216:219]
    v_mul_f32 v192, v192, v9
    v_mul_f32 v200, v200, v9
    v_mfma_f32_16x16x32_bf16 v[220:223], a[188:191], v[100:103], v[220:223]
    v_cvt_pk_bf16_f32 v192, v192, v193
    v_mul_f32 v202, v202, v9
    v_smfmac_f32_16x16x64_bf16 a[204:207], v[20:23], v[112:119], v29
    ds_read_b64_tr_b16 v[162:163], v36 offset:28672
    v_mul_f32 v194, v194, v9
    v_mul_f32 v196, v196, v9
    v_mul_f32 v209, v209, v9
    v_mfma_f32_16x16x32_bf16 v[224:227], a[208:211], v[112:115], v[224:227]
    v_mul_f32 v197, v197, v9
    v_mul_f32 v198, v198, v9
    v_cvt_pk_bf16_f32 v193, v194, v195
    v_cvt_pk_bf16_f32 v194, v196, v197
    v_cvt_pk_bf16_f32 v195, v198, v199
    v_mul_f32 v208, v208, v9
    v_mfma_f32_16x16x32_bf16 v[224:227], a[212:215], v[116:119], v[224:227]
    buffer_store_dwordx4 v[192:195], v28, s[24:27], s32 offen offset:0 sc1 nt
    v_mul_f32 v204, v204, v9
    v_mul_f32 v206, v206, v9
    v_mfma_f32_16x16x32_bf16 v[228:231], a[216:219], v[112:115], v[228:231]
    v_mul_f32 v203, v203, v9
    v_mul_f32 v210, v210, v9
    v_mfma_f32_16x16x32_bf16 v[228:231], a[220:223], v[116:119], v[228:231]
    v_mul_f32 v201, v201, v9
    v_cvt_pk_bf16_f32 v200, v200, v201
    v_cvt_pk_bf16_f32 v201, v202, v203
    v_mfma_f32_16x16x32_bf16 v[232:235], a[224:227], v[112:115], v[232:235]
    v_mul_f32 v205, v205, v9
    v_cvt_pk_bf16_f32 v202, v204, v205
    v_mul_f32 v211, v211, v9
    v_mul_f32 v219, v219, v9
    v_mfma_f32_16x16x32_bf16 v[232:235], a[228:231], v[116:119], v[232:235]
    ds_read_b128 a[220:223], v47 offset:16384
    v_cvt_pk_bf16_f32 v208, v208, v209
    v_mfma_f32_16x16x32_bf16 v[236:239], a[232:235], v[112:115], v[236:239]
    ds_read_b64_tr_b16 v[176:177], v38 offset:24576
    v_mul_f32 v207, v207, v9
    v_cvt_pk_bf16_f32 v203, v206, v207
    v_mfma_f32_16x16x32_bf16 v[236:239], a[236:239], v[116:119], v[236:239]
    buffer_store_dwordx4 v[200:203], v28, s[24:27], s32 offen offset:64 sc1 nt
    v_mul_f32 v213, v213, v9
    v_mul_f32 v214, v214, v9
    v_mfma_f32_16x16x32_bf16 v[240:243], a[240:243], v[112:115], v[240:243]
    v_mul_f32 v217, v217, v9
    v_mul_f32 v220, v220, v9
    v_mfma_f32_16x16x32_bf16 v[240:243], a[244:247], v[116:119], v[240:243]
    v_mul_f32 v215, v215, v9
    v_cvt_pk_bf16_f32 v209, v210, v211
    v_mfma_f32_16x16x32_bf16 v[244:247], a[248:251], v[112:115], v[244:247]
    v_cvt_pk_bf16_f32 v211, v214, v215
    v_mul_f32 v216, v216, v9
    v_mfma_f32_16x16x32_bf16 v[244:247], a[252:255], v[116:119], v[244:247]
    ds_read_b128 a[236:239], v47 offset:20480
    v_mul_f32 v212, v212, v9
    v_cvt_pk_bf16_f32 v210, v212, v213
    v_cvt_pk_bf16_f32 v216, v216, v217
    v_mfma_f32_16x16x32_bf16 v[248:251], a[0:3], v[112:115], v[248:251]
    buffer_store_dwordx4 v[208:211], v28, s[24:27], s32 offen offset:128 sc1 nt
    v_mul_f32 v218, v218, v9
    v_cvt_pk_bf16_f32 v217, v218, v219
    v_mfma_f32_16x16x32_bf16 v[248:251], a[4:7], v[116:119], v[248:251]
    ds_read_b128 a[208:211], v44 offset:16384
    v_mul_f32 v221, v221, v9
    v_mul_f32 v223, v223, v9
    v_mfma_f32_16x16x32_bf16 v[252:255], a[8:11], v[112:115], v[252:255]
    ds_read_b128 a[244:247], v45 offset:24576
    v_mul_f32 v222, v222, v9
    v_mfma_f32_16x16x32_bf16 v[252:255], a[12:15], v[116:119], v[252:255]
    ds_read_b128 a[228:231], v45 offset:20480
    v_cvt_pk_bf16_f32 v218, v220, v221
    v_mfma_f32_16x16x32_bf16 v[112:115], a[64:67], a[48:51], v[60:63]
    ds_read_b128 a[252:255], v47 offset:24576
    v_cvt_pk_bf16_f32 v219, v222, v223
    v_mfma_f32_16x16x32_bf16 v[112:115], a[68:71], a[52:55], v[112:115]
    buffer_store_dwordx4 v[216:219], v28, s[24:27], s32 offen offset:192 sc1 nt
    v_mfma_f32_16x16x32_bf16 v[112:115], a[72:75], a[56:59], v[112:115]
    ds_read_b128 a[212:215], v45 offset:16384
    v_mfma_f32_16x16x32_bf16 v[112:115], a[76:79], a[60:63], v[112:115]
    ds_read_b128 a[216:219], v46 offset:16384
    ds_read_b128 a[12:15], v47 offset:28672
    v_mfma_f32_16x16x32_bf16 v[116:119], a[80:83], a[48:51], v[60:63]
    ds_read_b128 a[232:235], v46 offset:20480
    v_mfma_f32_16x16x32_bf16 v[116:119], a[84:87], a[52:55], v[116:119]
    ds_read_b128 a[224:227], v44 offset:20480
    v_mfma_f32_16x16x32_bf16 v[116:119], a[88:91], a[56:59], v[116:119]
    ds_read_b128 a[4:7], v45 offset:28672
    v_mfma_f32_16x16x32_bf16 v[116:119], a[92:95], a[60:63], v[116:119]
    v_exp_f32 v113, v113
    v_mfma_f32_16x16x32_bf16 v[120:123], a[96:99], a[48:51], v[60:63]
    v_exp_f32 v114, v114
    v_mfma_f32_16x16x32_bf16 v[120:123], a[100:103], a[52:55], v[120:123]
    v_exp_f32 v115, v115
    v_mfma_f32_16x16x32_bf16 v[120:123], a[104:107], a[56:59], v[120:123]
    v_exp_f32 v112, v112
    v_mfma_f32_16x16x32_bf16 v[120:123], a[108:111], a[60:63], v[120:123]
    v_exp_f32 v117, v117
    v_mfma_f32_16x16x32_bf16 v[124:127], a[112:115], a[48:51], v[60:63]
    ds_read_b128 a[8:11], v46 offset:28672
    v_cvt_pk_bf16_f32 v112, v112, v113
    v_mfma_f32_16x16x32_bf16 v[124:127], a[116:119], a[52:55], v[124:127]
    ds_read_b64_tr_b16 v[164:165], v36 offset:24584
    v_cvt_pk_bf16_f32 v113, v114, v115
    v_mfma_f32_16x16x32_bf16 v[124:127], a[120:123], a[56:59], v[124:127]
    ds_read_b128 a[240:243], v44 offset:24576
    v_exp_f32 v119, v119
    v_mfma_f32_16x16x32_bf16 v[124:127], a[124:127], a[60:63], v[124:127]
    s_waitcnt lgkmcnt(3)
    v_exp_f32 v123, v123
    v_mfma_f32_16x16x32_bf16 v[64:67], a[208:211], a[48:51], v[60:63]
    ds_read_b128 a[248:251], v46 offset:24576
    v_exp_f32 v116, v116
    v_mfma_f32_16x16x32_bf16 v[64:67], a[212:215], a[52:55], v[64:67]
    v_exp_f32 v121, v121
    v_mfma_f32_16x16x32_bf16 v[64:67], a[216:219], a[56:59], v[64:67]
    ds_read_b128 a[0:3], v44 offset:28672
    v_exp_f32 v122, v122
    v_mfma_f32_16x16x32_bf16 v[64:67], a[220:223], a[60:63], v[64:67]
    v_exp_f32 v127, v127
    v_mfma_f32_16x16x32_bf16 v[68:71], a[224:227], a[48:51], v[60:63]
    v_exp_f32 v125, v125
    v_mfma_f32_16x16x32_bf16 v[68:71], a[228:231], a[52:55], v[68:71]
    v_exp_f32 v118, v118
    v_mfma_f32_16x16x32_bf16 v[68:71], a[232:235], a[56:59], v[68:71]
    s_waitcnt lgkmcnt(2)
    v_exp_f32 v120, v120
    v_mfma_f32_16x16x32_bf16 v[68:71], a[236:239], a[60:63], v[68:71]
    v_exp_f32 v124, v124
    v_mfma_f32_16x16x32_bf16 v[72:75], a[240:243], a[48:51], v[60:63]
    v_exp_f32 v126, v126
    v_mfma_f32_16x16x32_bf16 v[72:75], a[244:247], a[52:55], v[72:75]
    s_waitcnt lgkmcnt(1)
    v_cvt_pk_bf16_f32 v114, v116, v117
    v_cvt_pk_bf16_f32 v116, v120, v121
    v_mfma_f32_16x16x32_bf16 v[72:75], a[248:251], a[56:59], v[72:75]
    v_cvt_pk_bf16_f32 v115, v118, v119
    v_cvt_pk_bf16_f32 v119, v126, v127
    v_mfma_f32_16x16x32_bf16 v[72:75], a[252:255], a[60:63], v[72:75]
    s_waitcnt lgkmcnt(0)
    v_exp_f32 v65, v65
    v_mfma_f32_16x16x32_bf16 v[76:79], a[0:3], a[48:51], v[60:63]
    v_exp_f32 v68, v68
    v_mfma_f32_16x16x32_bf16 v[76:79], a[4:7], a[52:55], v[76:79]
    v_exp_f32 v66, v66
    v_mfma_f32_16x16x32_bf16 v[76:79], a[8:11], a[56:59], v[76:79]
    v_cvt_pk_bf16_f32 v117, v122, v123
    v_cvt_pk_bf16_f32 v118, v124, v125
    v_mfma_f32_16x16x32_bf16 v[76:79], a[12:15], a[60:63], v[76:79]
    v_exp_f32 v72, v72
    v_smfmac_f32_16x16x64_bf16 a[204:207], v[20:23], v[112:119], v29
    ds_read_b64_tr_b16 v[152:153], v39 offset:16384
    v_exp_f32 v70, v70
    v_mfma_f32_16x16x32_bf16 v[224:227], a[128:131], v[112:115], v[224:227]
    v_exp_f32 v64, v64
    v_mfma_f32_16x16x32_bf16 v[224:227], a[160:163], v[116:119], v[224:227]
    v_exp_f32 v74, v74
    v_mfma_f32_16x16x32_bf16 v[228:231], a[132:135], v[112:115], v[228:231]
    v_exp_f32 v67, v67
    v_mfma_f32_16x16x32_bf16 v[228:231], a[164:167], v[116:119], v[228:231]
    v_cvt_pk_bf16_f32 v64, v64, v65
    v_cvt_pk_bf16_f32 v65, v66, v67
    v_mfma_f32_16x16x32_bf16 v[232:235], a[136:139], v[112:115], v[232:235]
    v_exp_f32 v76, v76
    v_mfma_f32_16x16x32_bf16 v[232:235], a[168:171], v[116:119], v[232:235]
    v_exp_f32 v71, v71
    v_mfma_f32_16x16x32_bf16 v[236:239], a[140:143], v[112:115], v[236:239]
    v_exp_f32 v69, v69
    v_cvt_pk_bf16_f32 v67, v70, v71
    v_mfma_f32_16x16x32_bf16 v[236:239], a[172:175], v[116:119], v[236:239]
    ds_read_b64_tr_b16 v[134:135], v36 offset:20488
    v_cvt_pk_bf16_f32 v66, v68, v69
    v_mfma_f32_16x16x32_bf16 v[240:243], a[144:147], v[112:115], v[240:243]
    v_exp_f32 v78, v78
    v_mfma_f32_16x16x32_bf16 v[240:243], a[176:179], v[116:119], v[240:243]
    v_exp_f32 v77, v77
    v_mfma_f32_16x16x32_bf16 v[244:247], a[148:151], v[112:115], v[244:247]
    v_exp_f32 v73, v73
    v_mfma_f32_16x16x32_bf16 v[244:247], a[180:183], v[116:119], v[244:247]
    v_cvt_pk_bf16_f32 v68, v72, v73
    v_cvt_pk_bf16_f32 v70, v76, v77
    v_mfma_f32_16x16x32_bf16 v[248:251], a[152:155], v[112:115], v[248:251]
    v_exp_f32 v79, v79
    v_mfma_f32_16x16x32_bf16 v[248:251], a[184:187], v[116:119], v[248:251]
    v_exp_f32 v75, v75
    v_mfma_f32_16x16x32_bf16 v[252:255], a[156:159], v[112:115], v[252:255]
    v_cvt_pk_bf16_f32 v69, v74, v75
    v_cvt_pk_bf16_f32 v71, v78, v79
    v_mfma_f32_16x16x32_bf16 v[252:255], a[188:191], v[116:119], v[252:255]
    ds_read_b64_tr_b16 v[156:157], v39 offset:16392
    v_smfmac_f32_16x16x64_bf16 a[204:207], v[20:23], v[64:71], v29
    ds_read_b64_tr_b16 v[154:155], v39 offset:20480
    v_mfma_f32_16x16x32_bf16 v[224:227], v[128:131], v[64:67], v[224:227]
    ds_read_b64_tr_b16 v[184:185], v39 offset:24576
    v_mfma_f32_16x16x32_bf16 v[224:227], v[160:163], v[68:71], v[224:227]
    s_waitcnt lgkmcnt(3)
    ds_read_b64_tr_b16 v[190:191], v39 offset:28680
    v_mfma_f32_16x16x32_bf16 v[228:231], v[132:135], v[64:67], v[228:231]
    ds_read_b64_tr_b16 v[186:187], v39 offset:28672
    v_mfma_f32_16x16x32_bf16 v[228:231], v[164:167], v[68:71], v[228:231]
    v_accvgpr_read_b32 v11, a204
    v_accvgpr_read_b32 v13, a205
    v_mfma_f32_16x16x32_bf16 v[232:235], v[136:139], v[64:67], v[232:235]
    v_add_f32 v11, v11, v13
    v_cmp_ngt_f32 vcc, 0x53800000, v11
    v_mfma_f32_16x16x32_bf16 v[232:235], v[168:171], v[68:71], v[232:235]
    v_rcp_f32 v12, v11
    v_mfma_f32_16x16x32_bf16 v[236:239], v[140:143], v[64:67], v[236:239]
    v_mul_f32 v225, v225, v12
    v_mul_f32 v226, v226, v12
    v_mul_f32 v227, v227, v12
    v_mfma_f32_16x16x32_bf16 v[236:239], v[172:175], v[68:71], v[236:239]
    s_or_b64 s[46:47], s[46:47], vcc
    v_mul_f32 v224, v224, v12
    v_mul_f32 v228, v228, v12
    v_mul_f32 v229, v229, v12
    v_mul_f32 v230, v230, v12
    v_mul_f32 v231, v231, v12
    v_cvt_pk_bf16_f32 v224, v224, v225
    v_cvt_pk_bf16_f32 v225, v226, v227
    v_cvt_pk_bf16_f32 v226, v228, v229
    v_cvt_pk_bf16_f32 v227, v230, v231
    v_mfma_f32_16x16x32_bf16 v[240:243], v[144:147], v[64:67], v[240:243]
    buffer_store_dwordx4 v[224:227], v28, s[24:27], s33 offen offset:0 sc1 nt
    v_mfma_f32_16x16x32_bf16 v[240:243], v[176:179], v[68:71], v[240:243]
    s_waitcnt lgkmcnt(0)
    v_mul_f32 v233, v233, v12
    v_mul_f32 v234, v234, v12
    v_mul_f32 v235, v235, v12
    v_mfma_f32_16x16x32_bf16 v[244:247], v[148:151], v[64:67], v[244:247]
    v_mul_f32 v232, v232, v12
    v_cvt_pk_bf16_f32 v232, v232, v233
    v_cvt_pk_bf16_f32 v233, v234, v235
    v_mfma_f32_16x16x32_bf16 v[244:247], v[180:183], v[68:71], v[244:247]
    v_mul_f32 v237, v237, v12
    v_mul_f32 v238, v238, v12
    v_mul_f32 v239, v239, v12
    v_cvt_pk_bf16_f32 v235, v238, v239
    v_mfma_f32_16x16x32_bf16 v[248:251], v[152:155], v[64:67], v[248:251]
    v_mul_f32 v236, v236, v12
    v_cvt_pk_bf16_f32 v234, v236, v237
    v_mfma_f32_16x16x32_bf16 v[248:251], v[184:187], v[68:71], v[248:251]
    buffer_store_dwordx4 v[232:235], v28, s[24:27], s33 offen offset:64 sc1 nt
    v_mul_f32 v242, v242, v12
    v_mul_f32 v243, v243, v12
    v_mfma_f32_16x16x32_bf16 v[252:255], v[156:159], v[64:67], v[252:255]
    v_mul_f32 v240, v240, v12
    v_mul_f32 v241, v241, v12
    v_cvt_pk_bf16_f32 v240, v240, v241
    v_cvt_pk_bf16_f32 v241, v242, v243
    v_mfma_f32_16x16x32_bf16 v[252:255], v[188:191], v[68:71], v[252:255]
    v_mul_f32 v244, v244, v12
    v_mul_f32 v245, v245, v12
    v_mul_f32 v246, v246, v12
    v_mul_f32 v247, v247, v12
    v_cvt_pk_bf16_f32 v242, v244, v245
    v_cvt_pk_bf16_f32 v243, v246, v247
    v_mul_f32 v248, v248, v12
    v_mul_f32 v249, v249, v12
    v_mul_f32 v250, v250, v12
    v_mul_f32 v251, v251, v12
    v_cvt_pk_bf16_f32 v248, v248, v249
    v_cvt_pk_bf16_f32 v249, v250, v251
    buffer_store_dwordx4 v[240:243], v28, s[24:27], s33 offen offset:128 sc1 nt
    v_mul_f32 v252, v252, v12
    v_mul_f32 v253, v253, v12
    v_mul_f32 v254, v254, v12
    v_mul_f32 v255, v255, v12
    v_cvt_pk_bf16_f32 v250, v252, v253
    v_cvt_pk_bf16_f32 v251, v254, v255
    s_nop 7
    buffer_store_dwordx4 v[248:251], v28, s[24:27], s33 offen offset:192 sc1 nt
    s_cmp_eq_u32 s48, 1
    s_cbranch_scc1 L_end
    v_mov_b32 v5, 0x20000
    s_cmp_eq_u64 s[46:47], 0
    s_cbranch_scc1 L_noflag
    v_mov_b32 v6, 1
    ds_write_b32 v5, v6
L_noflag:
    s_waitcnt lgkmcnt(0)
    s_barrier
    ds_read_b32 v6, v5
    s_waitcnt lgkmcnt(0)
    v_readfirstlane_b32 s3, v6
    s_nop 3
    s_cmp_eq_u32 s3, 0
    s_cbranch_scc0 L_fallback
L_end:
    s_endpgm
L_fallback:
    s_waitcnt vmcnt(0)
    s_barrier
    s_mov_b32 s48, 1
    s_add_u32 m0, s44, 0x20000
    s_nop 0
    buffer_load_dwordx4 v32, s[12:15], s30 offen offset:0 lds
    buffer_load_dwordx4 v33, s[12:15], s30 offen offset:1024 lds
    buffer_load_dwordx4 v34, s[12:15], s30 offen offset:2048 lds
    buffer_load_dwordx4 v35, s[12:15], s30 offen offset:3072 lds
    s_waitcnt vmcnt(0)
    v_and_b32 v3, 15, v0
    v_bfe_u32 v4, v0, 4, 2
    s_add_u32 s34, s44, 0x18000
    v_add_u32 v16, s34, v44
    v_add_u32 v17, s34, v45
    v_add_u32 v18, s34, v46
    v_add_u32 v19, s34, v47
    v_lshrrev_b32 v5, 2, v3
    s_nop 1
    v_cmp_eq_u32 vcc, v5, v4
    s_nop 1
    v_and_b32 v5, 1, v3
    s_nop 1
    v_mov_b32 v11, 0xb9d8
    s_nop 1
    v_mov_b32 v10, 0x3e03
    s_nop 1
    v_lshlrev_b32 v5, 4, v5
    s_nop 1
    v_mov_b32 v8, 0
    s_nop 1
    v_and_b32 v6, 2, v3
    s_nop 1
    v_cndmask_b32 v6, 4, v6, vcc
    s_nop 1
    v_lshlrev_b32 v9, v5, v10
    s_nop 1
    v_lshlrev_b32 v11, v5, v11
    s_nop 1
    v_cmp_eq_u32 vcc, 0, v6
    s_nop 1
    v_accvgpr_write_b32 a208, v8
    s_nop 1
    v_accvgpr_write_b32 a209, v8
    s_nop 1
    v_accvgpr_write_b32 a212, v8
    s_nop 1
    v_accvgpr_write_b32 a213, v8
    s_nop 1
    v_accvgpr_write_b32 a216, v8
    s_nop 1
    v_accvgpr_write_b32 a217, v8
    s_nop 1
    v_cndmask_b32 v12, v8, v9, vcc
    s_nop 1
    v_cndmask_b32 v13, v8, v11, vcc
    s_nop 1
    v_cmp_eq_u32 vcc, 2, v6
    s_nop 1
    v_accvgpr_write_b32 a210, v12
    s_nop 1
    v_accvgpr_write_b32 a214, v13
    s_nop 1
    v_cndmask_b32 v12, v8, v9, vcc
    s_nop 1
    v_cndmask_b32 v13, v8, v11, vcc
    s_nop 1
    v_accvgpr_write_b32 a211, v12
    s_nop 1
    v_accvgpr_write_b32 a215, v13
    s_nop 1
    ds_read_b128 a[0:3], v16 offset:32768
    ds_read_b128 a[4:7], v17 offset:32768
    ds_read_b128 a[8:11], v18 offset:32768
    ds_read_b128 a[12:15], v19 offset:32768
    s_waitcnt lgkmcnt(0)
    v_mfma_f32_16x16x32_bf16 v[64:67], a[210:213], a[0:3], 0
    s_nop 7
    v_mfma_f32_16x16x32_bf16 v[64:67], a[214:217], a[0:3], v[64:67]
    s_nop 7
    v_mfma_f32_16x16x32_bf16 v[68:71], a[208:211], a[0:3], 0
    s_nop 7
    v_mfma_f32_16x16x32_bf16 v[68:71], a[212:215], a[0:3], v[68:71]
    s_nop 7
    v_cvt_pk_bf16_f32 v14, v64, v65
    s_nop 7
    v_accvgpr_write_b32 a0, v14
    s_nop 7
    v_cvt_pk_bf16_f32 v15, v66, v67
    s_nop 7
    v_accvgpr_write_b32 a1, v15
    s_nop 7
    v_cvt_pk_bf16_f32 v8, v68, v69
    s_nop 7
    v_accvgpr_write_b32 a2, v8
    s_nop 7
    v_cvt_pk_bf16_f32 v9, v70, v71
    s_nop 7
    v_accvgpr_write_b32 a3, v9
    s_nop 7
    v_mfma_f32_16x16x32_bf16 v[72:75], a[210:213], a[4:7], 0
    s_nop 7
    v_mfma_f32_16x16x32_bf16 v[72:75], a[214:217], a[4:7], v[72:75]
    s_nop 7
    v_mfma_f32_16x16x32_bf16 v[76:79], a[208:211], a[4:7], 0
    s_nop 7
    v_mfma_f32_16x16x32_bf16 v[76:79], a[212:215], a[4:7], v[76:79]
    s_nop 7
    v_cvt_pk_bf16_f32 v10, v72, v73
    s_nop 7
    v_accvgpr_write_b32 a4, v10
    s_nop 7
    v_cvt_pk_bf16_f32 v11, v74, v75
    s_nop 7
    v_accvgpr_write_b32 a5, v11
    s_nop 7
    v_cvt_pk_bf16_f32 v12, v76, v77
    s_nop 7
    v_accvgpr_write_b32 a6, v12
    s_nop 7
    v_cvt_pk_bf16_f32 v13, v78, v79
    s_nop 7
    v_accvgpr_write_b32 a7, v13
    s_nop 7
    v_mfma_f32_16x16x32_bf16 v[64:67], a[210:213], a[8:11], 0
    s_nop 7
    v_mfma_f32_16x16x32_bf16 v[64:67], a[214:217], a[8:11], v[64:67]
    s_nop 7
    v_mfma_f32_16x16x32_bf16 v[68:71], a[208:211], a[8:11], 0
    s_nop 7
    v_mfma_f32_16x16x32_bf16 v[68:71], a[212:215], a[8:11], v[68:71]
    s_nop 7
    v_cvt_pk_bf16_f32 v14, v64, v65
    s_nop 7
    v_accvgpr_write_b32 a8, v14
    s_nop 7
    v_cvt_pk_bf16_f32 v15, v66, v67
    s_nop 7
    v_accvgpr_write_b32 a9, v15
    s_nop 7
    v_cvt_pk_bf16_f32 v8, v68, v69
    s_nop 7
    v_accvgpr_write_b32 a10, v8
    s_nop 7
    v_cvt_pk_bf16_f32 v9, v70, v71
    s_nop 7
    v_accvgpr_write_b32 a11, v9
    s_nop 7
    v_mfma_f32_16x16x32_bf16 v[72:75], a[210:213], a[12:15], 0
    s_nop 7
    v_mfma_f32_16x16x32_bf16 v[72:75], a[214:217], a[12:15], v[72:75]
    s_nop 7
    v_mfma_f32_16x16x32_bf16 v[76:79], a[208:211], a[12:15], 0
    s_nop 7
    v_mfma_f32_16x16x32_bf16 v[76:79], a[212:215], a[12:15], v[76:79]
    s_nop 7
    v_cvt_pk_bf16_f32 v10, v72, v73
    s_nop 7
    v_accvgpr_write_b32 a12, v10
    s_nop 7
    v_cvt_pk_bf16_f32 v11, v74, v75
    s_nop 7
    v_accvgpr_write_b32 a13, v11
    s_nop 7
    v_cvt_pk_bf16_f32 v12, v76, v77
    s_nop 7
    v_accvgpr_write_b32 a14, v12
    s_nop 7
    v_cvt_pk_bf16_f32 v13, v78, v79
    s_nop 7
    v_accvgpr_write_b32 a15, v13
    s_nop 7
    s_mov_b32 s34, s8
    s_mov_b32 s35, 0
L_fb_loop:
    s_barrier
    s_mov_b32 m0, s44
    s_nop 0
    buffer_load_dwordx4 v32, s[16:19], s34 offen offset:0 lds
    buffer_load_dwordx4 v33, s[16:19], s34 offen offset:1024 lds
    buffer_load_dwordx4 v34, s[16:19], s34 offen offset:2048 lds
    buffer_load_dwordx4 v35, s[16:19], s34 offen offset:3072 lds
    s_waitcnt vmcnt(0)
    s_barrier
    ds_read_b128 a[64:67], v44 offset:0
    ds_read_b128 a[68:71], v45 offset:0
    ds_read_b128 a[72:75], v46 offset:0
    ds_read_b128 a[76:79], v47 offset:0
    ds_read_b128 a[80:83], v44 offset:4096
    s_waitcnt lgkmcnt(4)
    ds_read_b128 a[84:87], v45 offset:4096
    s_waitcnt lgkmcnt(4)
    ds_read_b128 a[88:91], v46 offset:4096
    s_waitcnt lgkmcnt(4)
    ds_read_b128 a[92:95], v47 offset:4096
    s_waitcnt lgkmcnt(4)
    ds_read_b128 a[96:99], v44 offset:8192
    ds_read_b128 a[100:103], v45 offset:8192
    ds_read_b128 a[104:107], v46 offset:8192
    ds_read_b128 a[108:111], v47 offset:8192
    ds_read_b128 a[112:115], v44 offset:12288
    s_waitcnt lgkmcnt(4)
    ds_read_b128 a[116:119], v45 offset:12288
    s_waitcnt lgkmcnt(4)
    ds_read_b128 a[120:123], v46 offset:12288
    s_waitcnt lgkmcnt(4)
    ds_read_b128 a[124:127], v47 offset:12288
    s_waitcnt lgkmcnt(4)
    s_waitcnt lgkmcnt(0)
    v_mfma_f32_16x16x32_bf16 v[64:67], a[64:67], a[0:3], 0
    v_mfma_f32_16x16x32_bf16 v[64:67], a[68:71], a[4:7], v[64:67]
    v_mfma_f32_16x16x32_bf16 v[64:67], a[72:75], a[8:11], v[64:67]
    v_mfma_f32_16x16x32_bf16 v[64:67], a[76:79], a[12:15], v[64:67]
    v_mfma_f32_16x16x32_bf16 v[68:71], a[80:83], a[0:3], 0
    v_mfma_f32_16x16x32_bf16 v[68:71], a[84:87], a[4:7], v[68:71]
    v_mfma_f32_16x16x32_bf16 v[68:71], a[88:91], a[8:11], v[68:71]
    v_mfma_f32_16x16x32_bf16 v[68:71], a[92:95], a[12:15], v[68:71]
    v_mfma_f32_16x16x32_bf16 v[72:75], a[96:99], a[0:3], 0
    v_mfma_f32_16x16x32_bf16 v[72:75], a[100:103], a[4:7], v[72:75]
    v_mfma_f32_16x16x32_bf16 v[72:75], a[104:107], a[8:11], v[72:75]
    v_mfma_f32_16x16x32_bf16 v[72:75], a[108:111], a[12:15], v[72:75]
    v_mfma_f32_16x16x32_bf16 v[76:79], a[112:115], a[0:3], 0
    v_mfma_f32_16x16x32_bf16 v[76:79], a[116:119], a[4:7], v[76:79]
    v_mfma_f32_16x16x32_bf16 v[76:79], a[120:123], a[8:11], v[76:79]
    v_mfma_f32_16x16x32_bf16 v[76:79], a[124:127], a[12:15], v[76:79]
    v_mfma_f32_16x16x32_bf16 v[80:83], a[64:67], a[16:19], 0
    v_mfma_f32_16x16x32_bf16 v[80:83], a[68:71], a[20:23], v[80:83]
    v_mfma_f32_16x16x32_bf16 v[80:83], a[72:75], a[24:27], v[80:83]
    v_mfma_f32_16x16x32_bf16 v[80:83], a[76:79], a[28:31], v[80:83]
    v_mfma_f32_16x16x32_bf16 v[84:87], a[80:83], a[16:19], 0
    v_mfma_f32_16x16x32_bf16 v[84:87], a[84:87], a[20:23], v[84:87]
    v_mfma_f32_16x16x32_bf16 v[84:87], a[88:91], a[24:27], v[84:87]
    v_mfma_f32_16x16x32_bf16 v[84:87], a[92:95], a[28:31], v[84:87]
    v_mfma_f32_16x16x32_bf16 v[88:91], a[96:99], a[16:19], 0
    v_mfma_f32_16x16x32_bf16 v[88:91], a[100:103], a[20:23], v[88:91]
    v_mfma_f32_16x16x32_bf16 v[88:91], a[104:107], a[24:27], v[88:91]
    v_mfma_f32_16x16x32_bf16 v[88:91], a[108:111], a[28:31], v[88:91]
    v_mfma_f32_16x16x32_bf16 v[92:95], a[112:115], a[16:19], 0
    v_mfma_f32_16x16x32_bf16 v[92:95], a[116:119], a[20:23], v[92:95]
    v_mfma_f32_16x16x32_bf16 v[92:95], a[120:123], a[24:27], v[92:95]
    v_mfma_f32_16x16x32_bf16 v[92:95], a[124:127], a[28:31], v[92:95]
    v_mfma_f32_16x16x32_bf16 v[96:99], a[64:67], a[32:35], 0
    v_mfma_f32_16x16x32_bf16 v[96:99], a[68:71], a[36:39], v[96:99]
    v_mfma_f32_16x16x32_bf16 v[96:99], a[72:75], a[40:43], v[96:99]
    v_mfma_f32_16x16x32_bf16 v[96:99], a[76:79], a[44:47], v[96:99]
    v_mfma_f32_16x16x32_bf16 v[100:103], a[80:83], a[32:35], 0
    v_mfma_f32_16x16x32_bf16 v[100:103], a[84:87], a[36:39], v[100:103]
    v_mfma_f32_16x16x32_bf16 v[100:103], a[88:91], a[40:43], v[100:103]
    v_mfma_f32_16x16x32_bf16 v[100:103], a[92:95], a[44:47], v[100:103]
    v_mfma_f32_16x16x32_bf16 v[104:107], a[96:99], a[32:35], 0
    v_mfma_f32_16x16x32_bf16 v[104:107], a[100:103], a[36:39], v[104:107]
    v_mfma_f32_16x16x32_bf16 v[104:107], a[104:107], a[40:43], v[104:107]
    v_mfma_f32_16x16x32_bf16 v[104:107], a[108:111], a[44:47], v[104:107]
    v_mfma_f32_16x16x32_bf16 v[108:111], a[112:115], a[32:35], 0
    v_mfma_f32_16x16x32_bf16 v[108:111], a[116:119], a[36:39], v[108:111]
    v_mfma_f32_16x16x32_bf16 v[108:111], a[120:123], a[40:43], v[108:111]
    v_mfma_f32_16x16x32_bf16 v[108:111], a[124:127], a[44:47], v[108:111]
    v_mfma_f32_16x16x32_bf16 v[112:115], a[64:67], a[48:51], 0
    v_mfma_f32_16x16x32_bf16 v[112:115], a[68:71], a[52:55], v[112:115]
    v_mfma_f32_16x16x32_bf16 v[112:115], a[72:75], a[56:59], v[112:115]
    v_mfma_f32_16x16x32_bf16 v[112:115], a[76:79], a[60:63], v[112:115]
    v_mfma_f32_16x16x32_bf16 v[116:119], a[80:83], a[48:51], 0
    v_mfma_f32_16x16x32_bf16 v[116:119], a[84:87], a[52:55], v[116:119]
    v_mfma_f32_16x16x32_bf16 v[116:119], a[88:91], a[56:59], v[116:119]
    v_mfma_f32_16x16x32_bf16 v[116:119], a[92:95], a[60:63], v[116:119]
    v_mfma_f32_16x16x32_bf16 v[120:123], a[96:99], a[48:51], 0
    v_mfma_f32_16x16x32_bf16 v[120:123], a[100:103], a[52:55], v[120:123]
    v_mfma_f32_16x16x32_bf16 v[120:123], a[104:107], a[56:59], v[120:123]
    v_mfma_f32_16x16x32_bf16 v[120:123], a[108:111], a[60:63], v[120:123]
    v_mfma_f32_16x16x32_bf16 v[124:127], a[112:115], a[48:51], 0
    v_mfma_f32_16x16x32_bf16 v[124:127], a[116:119], a[52:55], v[124:127]
    v_mfma_f32_16x16x32_bf16 v[124:127], a[120:123], a[56:59], v[124:127]
    v_mfma_f32_16x16x32_bf16 v[124:127], a[124:127], a[60:63], v[124:127]
    s_nop 15
    v_max3_f32 v24, v24, v64, v65
    v_max3_f32 v24, v24, v66, v67
    v_max3_f32 v24, v24, v68, v69
    v_max3_f32 v24, v24, v70, v71
    v_max3_f32 v24, v24, v72, v73
    v_max3_f32 v24, v24, v74, v75
    v_max3_f32 v24, v24, v76, v77
    v_max3_f32 v24, v24, v78, v79
    v_max3_f32 v25, v25, v80, v81
    v_max3_f32 v25, v25, v82, v83
    v_max3_f32 v25, v25, v84, v85
    v_max3_f32 v25, v25, v86, v87
    v_max3_f32 v25, v25, v88, v89
    v_max3_f32 v25, v25, v90, v91
    v_max3_f32 v25, v25, v92, v93
    v_max3_f32 v25, v25, v94, v95
    v_max3_f32 v26, v26, v96, v97
    v_max3_f32 v26, v26, v98, v99
    v_max3_f32 v26, v26, v100, v101
    v_max3_f32 v26, v26, v102, v103
    v_max3_f32 v26, v26, v104, v105
    v_max3_f32 v26, v26, v106, v107
    v_max3_f32 v26, v26, v108, v109
    v_max3_f32 v26, v26, v110, v111
    v_max3_f32 v27, v27, v112, v113
    v_max3_f32 v27, v27, v114, v115
    v_max3_f32 v27, v27, v116, v117
    v_max3_f32 v27, v27, v118, v119
    v_max3_f32 v27, v27, v120, v121
    v_max3_f32 v27, v27, v122, v123
    v_max3_f32 v27, v27, v124, v125
    v_max3_f32 v27, v27, v126, v127
    s_add_u32 s34, s34, 0x4000
    s_add_u32 s35, s35, 1
    s_cmp_lt_u32 s35, 8
    s_cbranch_scc1 L_fb_loop
    v_mov_b32 v8, v24
    s_nop 1
    v_permlane16_swap_b32 v24, v8
    s_nop 1
    v_max_f32 v24, v24, v8
    v_mov_b32 v8, v24
    s_nop 1
    v_permlane32_swap_b32 v24, v8
    s_nop 1
    v_max_f32 v24, v24, v8
    v_mov_b32 v8, v25
    s_nop 1
    v_permlane16_swap_b32 v25, v8
    s_nop 1
    v_max_f32 v25, v25, v8
    v_mov_b32 v8, v25
    s_nop 1
    v_permlane32_swap_b32 v25, v8
    s_nop 1
    v_max_f32 v25, v25, v8
    v_mov_b32 v8, v26
    s_nop 1
    v_permlane16_swap_b32 v26, v8
    s_nop 1
    v_max_f32 v26, v26, v8
    v_mov_b32 v8, v26
    s_nop 1
    v_permlane32_swap_b32 v26, v8
    s_nop 1
    v_max_f32 v26, v26, v8
    v_mov_b32 v8, v27
    s_nop 1
    v_permlane16_swap_b32 v27, v8
    s_nop 1
    v_max_f32 v27, v27, v8
    v_mov_b32 v8, v27
    s_nop 1
    v_permlane32_swap_b32 v27, v8
    s_nop 1
    v_max_f32 v27, v27, v8
    s_barrier
    s_branch L_restart
    s_endpgm
.fill 4096, 4, 0xbf800000
.section .rodata,"a"
.p2align 6
.amdhsa_kernel standalone__gqa_softmax__near_ridge_kernel
  .amdhsa_next_free_vgpr 512
  .amdhsa_next_free_sgpr 102
  .amdhsa_accum_offset 256
  .amdhsa_group_segment_fixed_size 0
  .amdhsa_kernarg_size 48
  .amdhsa_user_sgpr_count 2
  .amdhsa_user_sgpr_kernarg_segment_ptr 1
  .amdhsa_system_sgpr_workgroup_id_x 1
.end_amdhsa_kernel
```
